```python
import torch

def _softmax(x, axis=-1):
    return torch.softmax(x, dim=axis)
def _gelu(x):
    return torch.nn.functional.gelu(x, approximate="tanh")
def _silu(x):
    return torch.nn.functional.silu(x)
def _sigmoid(x):
    return torch.sigmoid(x)
def _layernorm(x, axis=-1, eps=1e-5):
    m = x.mean(dim=axis, keepdim=True)
    v = x.var(dim=axis, keepdim=True, unbiased=False)
    return (x - m) / torch.sqrt(v + eps)
def _scatter_add(tgt, idx, src, axis=0):
    return tgt.clone().index_add_(axis, idx, src)
def _segment_sum(src, seg, n):
    out = torch.zeros((n,) + src.shape[1:], dtype=src.dtype)
    return out.index_add_(0, seg, src)
def _pad(x, pw):
    flat = tuple(v for pair in reversed(pw) for v in pair)
    return torch.nn.functional.pad(x, flat)

kernel_name = 'standalone__linear_kernel_rfa__prompt'

def setup_inputs():

    _w = (lambda a: (lambda t: t.to(torch.bfloat16) if t.is_floating_point() else t)(torch.as_tensor(a)))
    B, H, Sq, Sk, D, M = 1, 32, 2048, 2048, 192, 64
    return {
        "q": _w((lambda *s: torch.randn(*s, dtype=torch.bfloat16) * 0.1)(B, H, Sq, D)),
        "k": _w((lambda *s: torch.randn(*s, dtype=torch.bfloat16) * 1.6)(B, H, Sk, D)),
        "v": _w((lambda *s: torch.randn(*s, dtype=torch.bfloat16) * 1.6)(B, H, Sk, D)),
        "omega": _w((lambda *s: torch.randn(*s, dtype=torch.bfloat16) * 1.6)(M, D)),
    }

def reference(q, k, v, omega):
    d = q.shape[-1]
    m = omega.shape[0]
    scale = float(d) ** -0.25
    qs = q * scale
    ks = k * scale
    q_proj = torch.einsum("bhsd,md->bhsm", qs, omega)
    k_proj = torch.einsum("bhsd,md->bhsm", ks, omega)
    q_sq = 0.5 * torch.einsum("bhsd,bhsd->bhs", qs, qs)[..., None]
    k_sq = 0.5 * torch.einsum("bhsd,bhsd->bhs", ks, ks)[..., None]
    inv_sqrt_m = float(m) ** -0.5
    phi_q = torch.exp(q_proj - q_sq) * inv_sqrt_m + 1e-6
    phi_k = torch.exp(k_proj - k_sq) * inv_sqrt_m + 1e-6
    kv = torch.einsum("bhsm,bhsd->bhmd", phi_k, v)
    z  = torch.einsum("bhsm->bhm", phi_k)
    num = torch.einsum("bhqm,bhmd->bhqd", phi_q, kv)
    den = torch.einsum("bhqm,bhm->bhq", phi_q, z)[..., None] + 1e-6
    return num / den
```

```asm
; @launch kernel=rfa_partial_kernel grid=(256,1,1) block=(512,1,1) lds=157760
; @launch kernel=rfa_output_kernel grid=(256,1,1) block=(512,1,1) lds=152576
.amdgcn_target "amdgcn-amd-amdhsa--gfx950"
.text
.p2align 8
.globl rfa_partial_kernel
.type rfa_partial_kernel,@function
rfa_partial_kernel:
    s_cmp_ge_u32 s2, 256
    s_cbranch_scc1 L_exit
    s_load_dwordx8 s[4:11], s[0:1], 0
    s_load_dwordx4 s[12:15], s[0:1], 32
    s_load_dwordx2 s[16:17], s[0:1], 48
    v_lshrrev_b32 v22, 6, v0
    s_nop 0
    v_readfirstlane_b32 s48, v22
    v_and_b32 v0, 63, v0
    s_and_b32 s60, s2, 7
    s_lshr_b32 s61, s2, 3
    s_and_b32 s61, s61, 3
    s_lshr_b32 s50, s2, 5
    s_lshl_b32 s60, s60, 2
    s_add_u32 s49, s60, s61
    s_mov_b32 s51, s50
    s_mov_b32 s72, 0
    s_mov_b32 s73, 0
    s_mov_b32 s74, 0
    s_mov_b32 s52, 0x3e898b82
    s_mov_b32 s53, 0x3fb8aa3b
    s_mov_b32 s54, 0x358637bd
    s_mov_b32 s55, 0x3e000000
    v_and_b32 v1, 31, v0
    v_lshrrev_b32 v2, 5, v0
    v_and_b32 v3, 15, v0
    v_lshrrev_b32 v4, 4, v0
    v_lshrrev_b32 v5, 2, v3
    v_and_b32 v6, 3, v3
    v_mov_b32 v21, 0
    v_lshlrev_b32 v19, 4, v0
    s_and_b32 s77, s48, 1
    s_lshr_b32 s78, s48, 1
    s_waitcnt lgkmcnt(0)
    s_mov_b32 s20, s4
    s_and_b32 s21, s5, 0xffff
    s_mov_b32 s22, 0x1800000
    s_mov_b32 s23, 0x00020000
    s_mov_b32 s24, s6
    s_and_b32 s25, s7, 0xffff
    s_mov_b32 s26, 0x1800000
    s_mov_b32 s27, 0x00020000
    s_mov_b32 s28, s8
    s_and_b32 s29, s9, 0xffff
    s_mov_b32 s30, 0x1800000
    s_mov_b32 s31, 0x00020000
    s_mov_b32 s32, s10
    s_and_b32 s33, s11, 0xffff
    s_mov_b32 s34, 0x6000
    s_mov_b32 s35, 0x00020000
    s_mov_b32 s36, s12
    s_and_b32 s37, s13, 0xffff
    s_mov_b32 s38, 0x1800000
    s_mov_b32 s39, 0x00020000
    s_mov_b32 s40, s14
    s_and_b32 s41, s15, 0xffff
    s_mov_b32 s42, 0x100
    s_mov_b32 s43, 0x00020000
    s_mov_b32 s44, s16
    s_and_b32 s45, s17, 0xffff
    s_mov_b32 s46, 0x10000000
    s_mov_b32 s47, 0x00020000
    s_mul_i32 s60, s49, 786432
    s_mul_i32 s61, s50, 98304
    s_add_u32 s56, s60, s61
    s_mov_b32 s57, s56
    s_mov_b32 s62, 384
    v_lshlrev_b32 v23, 5, v2
    v_mad_u32_u24 v7, s62, v1, v23
    v_lshrrev_b32 v22, 3, v0
    v_and_b32 v23, 7, v0
    v_lshrrev_b32 v24, 1, v23
    v_and_b32 v23, 1, v23
    v_lshrrev_b32 v25, 1, v22
    v_and_b32 v25, 1, v25
    v_xor_b32 v26, v24, v25
    v_lshlrev_b32 v26, 5, v26
    v_lshlrev_b32 v23, 4, v23
    v_mul_u32_u24 v22, s62, v22
    v_add3_u32 v8, v22, v23, v26
    v_xor_b32 v26, 64, v26
    v_add3_u32 v9, v22, v23, v26
    s_mul_i32 s63, s48, 4352
    s_add_u32 s63, s63, 122880
    s_mov_b32 s64, 136
    v_lshlrev_b32 v22, 3, v2
    v_mad_u32_u24 v22, s64, v1, v22
    v_add_u32 v10, s63, v22
    s_lshl_b32 s65, s77, 6
    s_add_u32 s65, s65, 122880
    v_lshl_add_u32 v22, v4, 3, v5
    v_mul_u32_u24 v22, s64, v22
    v_lshl_add_u32 v22, v6, 3, v22
    v_add_u32 v11, s65, v22
    v_lshlrev_b32 v22, 7, v5
    v_lshl_add_u32 v22, v6, 3, v22
    s_mov_b32 s66, 3072
    v_mad_u32_u24 v22, s66, v4, v22
    v_lshrrev_b32 v23, 1, v5
    v_and_b32 v23, 1, v23
    v_and_b32 v24, 1, v4
    v_lshl_add_u32 v23, v24, 1, v23
    v_lshl_add_u32 v22, v23, 5, v22
    v_add_u32 v22, 24576, v22
    s_mul_i32 s67, s78, 3
    s_add_u32 s67, s67, 0
    s_and_b32 s68, s67, 3
    s_lshl_b32 s68, s68, 5
    s_lshr_b32 s67, s67, 2
    s_lshl_b32 s67, s67, 10
    v_xor_b32 v23, s68, v22
    v_add_u32 v12, s67, v23
    s_add_u32 s67, s67, 49152
    v_add_u32 v13, s67, v23
    s_mul_i32 s67, s78, 3
    s_add_u32 s67, s67, 1
    s_and_b32 s68, s67, 3
    s_lshl_b32 s68, s68, 5
    s_lshr_b32 s67, s67, 2
    s_lshl_b32 s67, s67, 10
    v_xor_b32 v23, s68, v22
    v_add_u32 v14, s67, v23
    s_add_u32 s67, s67, 49152
    v_add_u32 v15, s67, v23
    s_mul_i32 s67, s78, 3
    s_add_u32 s67, s67, 2
    s_and_b32 s68, s67, 3
    s_lshl_b32 s68, s68, 5
    s_lshr_b32 s67, s67, 2
    s_lshl_b32 s67, s67, 10
    v_xor_b32 v23, s68, v22
    v_add_u32 v16, s67, v23
    s_add_u32 s67, s67, 49152
    v_add_u32 v17, s67, v23
    v_lshrrev_b32 v22, 1, v4
    v_lshlrev_b32 v22, 10, v22
    v_and_b32 v23, 1, v4
    v_lshl_or_b32 v22, v23, 9, v22
    v_lshl_add_u32 v18, v3, 4, v22
    v_lshlrev_b32 v22, 3, v2
    v_add_u32 v20, 49152, v22
    s_and_b32 s60, s48, 3
    s_lshr_b32 s61, s48, 2
    s_mul_i32 s61, s61, 12288
    s_mul_i32 s62, s48, 3072
    s_mul_i32 s63, s60, 3
    s_add_u32 s63, s63, 0
    s_and_b32 s64, s63, 1
    s_lshl_b32 s64, s64, 4
    s_lshr_b32 s63, s63, 1
    s_lshl_b32 s63, s63, 6
    s_add_u32 s63, s63, s64
    s_add_u32 s63, s63, s61
    s_add_u32 s64, s62, 0
    s_mov_b32 m0, s64
    s_nop 0
    buffer_load_dwordx4 v7, s[32:35], s63 offen offset:0 lds
    s_mul_i32 s63, s60, 3
    s_add_u32 s63, s63, 1
    s_and_b32 s64, s63, 1
    s_lshl_b32 s64, s64, 4
    s_lshr_b32 s63, s63, 1
    s_lshl_b32 s63, s63, 6
    s_add_u32 s63, s63, s64
    s_add_u32 s63, s63, s61
    s_add_u32 s64, s62, 1024
    s_mov_b32 m0, s64
    s_nop 0
    buffer_load_dwordx4 v7, s[32:35], s63 offen offset:0 lds
    s_mul_i32 s63, s60, 3
    s_add_u32 s63, s63, 2
    s_and_b32 s64, s63, 1
    s_lshl_b32 s64, s64, 4
    s_lshr_b32 s63, s63, 1
    s_lshl_b32 s63, s63, 6
    s_add_u32 s63, s63, s64
    s_add_u32 s63, s63, s61
    s_add_u32 s64, s62, 2048
    s_mov_b32 m0, s64
    s_nop 0
    buffer_load_dwordx4 v7, s[32:35], s63 offen offset:0 lds
    s_mul_i32 s60, s48, 12288
    s_add_u32 s60, s60, s57
    buffer_load_dwordx4 v[32:35], v7, s[24:27], s60 offen offset:0
    buffer_load_dwordx4 v[36:39], v7, s[24:27], s60 offen offset:16
    buffer_load_dwordx4 v[40:43], v7, s[24:27], s60 offen offset:64
    buffer_load_dwordx4 v[44:47], v7, s[24:27], s60 offen offset:80
    buffer_load_dwordx4 v[48:51], v7, s[24:27], s60 offen offset:128
    buffer_load_dwordx4 v[52:55], v7, s[24:27], s60 offen offset:144
    buffer_load_dwordx4 v[56:59], v7, s[24:27], s60 offen offset:192
    buffer_load_dwordx4 v[60:63], v7, s[24:27], s60 offen offset:208
    buffer_load_dwordx4 v[64:67], v7, s[24:27], s60 offen offset:256
    buffer_load_dwordx4 v[68:71], v7, s[24:27], s60 offen offset:272
    buffer_load_dwordx4 v[72:75], v7, s[24:27], s60 offen offset:320
    buffer_load_dwordx4 v[76:79], v7, s[24:27], s60 offen offset:336
    s_mul_i32 s80, s48, 12288
    s_add_u32 s80, s80, s57
    s_mul_i32 s81, s48, 12288
    s_add_u32 s81, s81, 24576
    s_waitcnt vmcnt(12)
    s_barrier
    ds_read_b128 v[160:163], v19 offset:0
    ds_read_b128 v[164:167], v19 offset:12288
    ds_read_b128 v[168:171], v19 offset:1024
    ds_read_b128 v[172:175], v19 offset:13312
    ds_read_b128 v[176:179], v19 offset:2048
    ds_read_b128 v[180:183], v19 offset:14336
    ds_read_b128 v[184:187], v19 offset:3072
    ds_read_b128 v[188:191], v19 offset:15360
    v_mov_b32 v255, 0
    ds_read_b128 v[192:195], v19 offset:4096
    ds_read_b128 v[196:199], v19 offset:16384
    ds_read_b128 v[200:203], v19 offset:5120
    ds_read_b128 v[204:207], v19 offset:17408
    ds_read_b128 v[208:211], v19 offset:6144
    ds_read_b128 v[212:215], v19 offset:18432
    ds_read_b128 v[216:219], v19 offset:7168
    ds_read_b128 v[220:223], v19 offset:19456
    s_waitcnt vmcnt(11)
    v_lshlrev_b32 v240, 16, v32
    v_and_b32 v241, 0xffff0000, v32
    v_lshlrev_b32 v242, 16, v33
    v_and_b32 v243, 0xffff0000, v33
    v_lshlrev_b32 v244, 16, v34
    v_and_b32 v245, 0xffff0000, v34
    v_lshlrev_b32 v246, 16, v35
    v_and_b32 v247, 0xffff0000, v35
    v_mul_f32 v240, s52, v240
    v_mul_f32 v241, s52, v241
    v_mul_f32 v242, s52, v242
    v_mul_f32 v243, s52, v243
    v_mul_f32 v244, s52, v244
    v_mul_f32 v245, s52, v245
    v_mul_f32 v246, s52, v246
    v_mul_f32 v247, s52, v247
    v_cvt_pk_bf16_f32 v32, v240, v241
    v_cvt_pk_bf16_f32 v33, v242, v243
    v_cvt_pk_bf16_f32 v34, v244, v245
    v_cvt_pk_bf16_f32 v35, v246, v247
    v_dot2c_f32_bf16 v255, v32, v32
    v_dot2c_f32_bf16 v255, v33, v33
    v_dot2c_f32_bf16 v255, v34, v34
    v_dot2c_f32_bf16 v255, v35, v35
    s_waitcnt lgkmcnt(8)
    v_mfma_f32_32x32x16_bf16 v[128:143], v[160:163], v[32:35], 0
    v_mfma_f32_32x32x16_bf16 v[144:159], v[164:167], v[32:35], 0
    s_add_u32 s82, s80, 0
    s_add_u32 s83, s81, 0
    s_mov_b32 m0, s83
    s_nop 0
    buffer_load_dwordx4 v8, s[28:31], s82 offen offset:0 lds
    s_waitcnt vmcnt(11)
    v_lshlrev_b32 v240, 16, v36
    v_and_b32 v241, 0xffff0000, v36
    v_lshlrev_b32 v242, 16, v37
    v_and_b32 v243, 0xffff0000, v37
    v_lshlrev_b32 v244, 16, v38
    v_and_b32 v245, 0xffff0000, v38
    v_lshlrev_b32 v246, 16, v39
    v_and_b32 v247, 0xffff0000, v39
    v_mul_f32 v240, s52, v240
    v_mul_f32 v241, s52, v241
    v_mul_f32 v242, s52, v242
    v_mul_f32 v243, s52, v243
    v_mul_f32 v244, s52, v244
    v_mul_f32 v245, s52, v245
    v_mul_f32 v246, s52, v246
    v_mul_f32 v247, s52, v247
    v_cvt_pk_bf16_f32 v36, v240, v241
    v_cvt_pk_bf16_f32 v37, v242, v243
    v_cvt_pk_bf16_f32 v38, v244, v245
    v_cvt_pk_bf16_f32 v39, v246, v247
    v_dot2c_f32_bf16 v255, v36, v36
    v_dot2c_f32_bf16 v255, v37, v37
    v_dot2c_f32_bf16 v255, v38, v38
    v_dot2c_f32_bf16 v255, v39, v39
    v_mfma_f32_32x32x16_bf16 v[128:143], v[168:171], v[36:39], v[128:143]
    v_mfma_f32_32x32x16_bf16 v[144:159], v[172:175], v[36:39], v[144:159]
    s_add_u32 s82, s80, 128
    s_add_u32 s83, s81, 1024
    s_mov_b32 m0, s83
    s_nop 0
    buffer_load_dwordx4 v8, s[28:31], s82 offen offset:0 lds
    s_waitcnt vmcnt(11)
    v_lshlrev_b32 v240, 16, v40
    v_and_b32 v241, 0xffff0000, v40
    v_lshlrev_b32 v242, 16, v41
    v_and_b32 v243, 0xffff0000, v41
    v_lshlrev_b32 v244, 16, v42
    v_and_b32 v245, 0xffff0000, v42
    v_lshlrev_b32 v246, 16, v43
    v_and_b32 v247, 0xffff0000, v43
    v_mul_f32 v240, s52, v240
    v_mul_f32 v241, s52, v241
    v_mul_f32 v242, s52, v242
    v_mul_f32 v243, s52, v243
    v_mul_f32 v244, s52, v244
    v_mul_f32 v245, s52, v245
    v_mul_f32 v246, s52, v246
    v_mul_f32 v247, s52, v247
    v_cvt_pk_bf16_f32 v40, v240, v241
    v_cvt_pk_bf16_f32 v41, v242, v243
    v_cvt_pk_bf16_f32 v42, v244, v245
    v_cvt_pk_bf16_f32 v43, v246, v247
    v_dot2c_f32_bf16 v255, v40, v40
    v_dot2c_f32_bf16 v255, v41, v41
    v_dot2c_f32_bf16 v255, v42, v42
    v_dot2c_f32_bf16 v255, v43, v43
    v_mfma_f32_32x32x16_bf16 v[128:143], v[176:179], v[40:43], v[128:143]
    v_mfma_f32_32x32x16_bf16 v[144:159], v[180:183], v[40:43], v[144:159]
    s_add_u32 s82, s80, 256
    s_add_u32 s83, s81, 2048
    s_mov_b32 m0, s83
    s_nop 0
    buffer_load_dwordx4 v8, s[28:31], s82 offen offset:0 lds
    s_waitcnt vmcnt(11)
    v_lshlrev_b32 v240, 16, v44
    v_and_b32 v241, 0xffff0000, v44
    v_lshlrev_b32 v242, 16, v45
    v_and_b32 v243, 0xffff0000, v45
    v_lshlrev_b32 v244, 16, v46
    v_and_b32 v245, 0xffff0000, v46
    v_lshlrev_b32 v246, 16, v47
    v_and_b32 v247, 0xffff0000, v47
    v_mul_f32 v240, s52, v240
    v_mul_f32 v241, s52, v241
    v_mul_f32 v242, s52, v242
    v_mul_f32 v243, s52, v243
    v_mul_f32 v244, s52, v244
    v_mul_f32 v245, s52, v245
    v_mul_f32 v246, s52, v246
    v_mul_f32 v247, s52, v247
    v_cvt_pk_bf16_f32 v44, v240, v241
    v_cvt_pk_bf16_f32 v45, v242, v243
    v_cvt_pk_bf16_f32 v46, v244, v245
    v_cvt_pk_bf16_f32 v47, v246, v247
    v_dot2c_f32_bf16 v255, v44, v44
    v_dot2c_f32_bf16 v255, v45, v45
    v_dot2c_f32_bf16 v255, v46, v46
    v_dot2c_f32_bf16 v255, v47, v47
    v_mfma_f32_32x32x16_bf16 v[128:143], v[184:187], v[44:47], v[128:143]
    v_mfma_f32_32x32x16_bf16 v[144:159], v[188:191], v[44:47], v[144:159]
    s_add_u32 s82, s80, 3072
    s_add_u32 s83, s81, 3072
    s_mov_b32 m0, s83
    s_nop 0
    buffer_load_dwordx4 v9, s[28:31], s82 offen offset:0 lds
    ds_read_b128 v[160:163], v19 offset:8192
    ds_read_b128 v[164:167], v19 offset:20480
    ds_read_b128 v[168:171], v19 offset:9216
    ds_read_b128 v[172:175], v19 offset:21504
    ds_read_b128 v[176:179], v19 offset:10240
    ds_read_b128 v[180:183], v19 offset:22528
    ds_read_b128 v[184:187], v19 offset:11264
    ds_read_b128 v[188:191], v19 offset:23552
    s_waitcnt vmcnt(11)
    v_lshlrev_b32 v240, 16, v48
    v_and_b32 v241, 0xffff0000, v48
    v_lshlrev_b32 v242, 16, v49
    v_and_b32 v243, 0xffff0000, v49
    v_lshlrev_b32 v244, 16, v50
    v_and_b32 v245, 0xffff0000, v50
    v_lshlrev_b32 v246, 16, v51
    v_and_b32 v247, 0xffff0000, v51
    v_mul_f32 v240, s52, v240
    v_mul_f32 v241, s52, v241
    v_mul_f32 v242, s52, v242
    v_mul_f32 v243, s52, v243
    v_mul_f32 v244, s52, v244
    v_mul_f32 v245, s52, v245
    v_mul_f32 v246, s52, v246
    v_mul_f32 v247, s52, v247
    v_cvt_pk_bf16_f32 v48, v240, v241
    v_cvt_pk_bf16_f32 v49, v242, v243
    v_cvt_pk_bf16_f32 v50, v244, v245
    v_cvt_pk_bf16_f32 v51, v246, v247
    v_dot2c_f32_bf16 v255, v48, v48
    v_dot2c_f32_bf16 v255, v49, v49
    v_dot2c_f32_bf16 v255, v50, v50
    v_dot2c_f32_bf16 v255, v51, v51
    s_waitcnt lgkmcnt(8)
    v_mfma_f32_32x32x16_bf16 v[128:143], v[192:195], v[48:51], v[128:143]
    v_mfma_f32_32x32x16_bf16 v[144:159], v[196:199], v[48:51], v[144:159]
    s_add_u32 s82, s80, 3200
    s_add_u32 s83, s81, 4096
    s_mov_b32 m0, s83
    s_nop 0
    buffer_load_dwordx4 v9, s[28:31], s82 offen offset:0 lds
    s_waitcnt vmcnt(11)
    v_lshlrev_b32 v240, 16, v52
    v_and_b32 v241, 0xffff0000, v52
    v_lshlrev_b32 v242, 16, v53
    v_and_b32 v243, 0xffff0000, v53
    v_lshlrev_b32 v244, 16, v54
    v_and_b32 v245, 0xffff0000, v54
    v_lshlrev_b32 v246, 16, v55
    v_and_b32 v247, 0xffff0000, v55
    v_mul_f32 v240, s52, v240
    v_mul_f32 v241, s52, v241
    v_mul_f32 v242, s52, v242
    v_mul_f32 v243, s52, v243
    v_mul_f32 v244, s52, v244
    v_mul_f32 v245, s52, v245
    v_mul_f32 v246, s52, v246
    v_mul_f32 v247, s52, v247
    v_cvt_pk_bf16_f32 v52, v240, v241
    v_cvt_pk_bf16_f32 v53, v242, v243
    v_cvt_pk_bf16_f32 v54, v244, v245
    v_cvt_pk_bf16_f32 v55, v246, v247
    v_dot2c_f32_bf16 v255, v52, v52
    v_dot2c_f32_bf16 v255, v53, v53
    v_dot2c_f32_bf16 v255, v54, v54
    v_dot2c_f32_bf16 v255, v55, v55
    v_mfma_f32_32x32x16_bf16 v[128:143], v[200:203], v[52:55], v[128:143]
    v_mfma_f32_32x32x16_bf16 v[144:159], v[204:207], v[52:55], v[144:159]
    s_add_u32 s82, s80, 3328
    s_add_u32 s83, s81, 5120
    s_mov_b32 m0, s83
    s_nop 0
    buffer_load_dwordx4 v9, s[28:31], s82 offen offset:0 lds
    s_waitcnt vmcnt(11)
    v_lshlrev_b32 v240, 16, v56
    v_and_b32 v241, 0xffff0000, v56
    v_lshlrev_b32 v242, 16, v57
    v_and_b32 v243, 0xffff0000, v57
    v_lshlrev_b32 v244, 16, v58
    v_and_b32 v245, 0xffff0000, v58
    v_lshlrev_b32 v246, 16, v59
    v_and_b32 v247, 0xffff0000, v59
    v_mul_f32 v240, s52, v240
    v_mul_f32 v241, s52, v241
    v_mul_f32 v242, s52, v242
    v_mul_f32 v243, s52, v243
    v_mul_f32 v244, s52, v244
    v_mul_f32 v245, s52, v245
    v_mul_f32 v246, s52, v246
    v_mul_f32 v247, s52, v247
    v_cvt_pk_bf16_f32 v56, v240, v241
    v_cvt_pk_bf16_f32 v57, v242, v243
    v_cvt_pk_bf16_f32 v58, v244, v245
    v_cvt_pk_bf16_f32 v59, v246, v247
    v_dot2c_f32_bf16 v255, v56, v56
    v_dot2c_f32_bf16 v255, v57, v57
    v_dot2c_f32_bf16 v255, v58, v58
    v_dot2c_f32_bf16 v255, v59, v59
    v_mfma_f32_32x32x16_bf16 v[128:143], v[208:211], v[56:59], v[128:143]
    v_mfma_f32_32x32x16_bf16 v[144:159], v[212:215], v[56:59], v[144:159]
    s_add_u32 s82, s80, 6144
    s_add_u32 s83, s81, 6144
    s_mov_b32 m0, s83
    s_nop 0
    buffer_load_dwordx4 v8, s[28:31], s82 offen offset:0 lds
    s_waitcnt vmcnt(11)
    v_lshlrev_b32 v240, 16, v60
    v_and_b32 v241, 0xffff0000, v60
    v_lshlrev_b32 v242, 16, v61
    v_and_b32 v243, 0xffff0000, v61
    v_lshlrev_b32 v244, 16, v62
    v_and_b32 v245, 0xffff0000, v62
    v_lshlrev_b32 v246, 16, v63
    v_and_b32 v247, 0xffff0000, v63
    v_mul_f32 v240, s52, v240
    v_mul_f32 v241, s52, v241
    v_mul_f32 v242, s52, v242
    v_mul_f32 v243, s52, v243
    v_mul_f32 v244, s52, v244
    v_mul_f32 v245, s52, v245
    v_mul_f32 v246, s52, v246
    v_mul_f32 v247, s52, v247
    v_cvt_pk_bf16_f32 v60, v240, v241
    v_cvt_pk_bf16_f32 v61, v242, v243
    v_cvt_pk_bf16_f32 v62, v244, v245
    v_cvt_pk_bf16_f32 v63, v246, v247
    v_dot2c_f32_bf16 v255, v60, v60
    v_dot2c_f32_bf16 v255, v61, v61
    v_dot2c_f32_bf16 v255, v62, v62
    v_dot2c_f32_bf16 v255, v63, v63
    v_mfma_f32_32x32x16_bf16 v[128:143], v[216:219], v[60:63], v[128:143]
    v_mfma_f32_32x32x16_bf16 v[144:159], v[220:223], v[60:63], v[144:159]
    s_add_u32 s82, s80, 6272
    s_add_u32 s83, s81, 7168
    s_mov_b32 m0, s83
    s_nop 0
    buffer_load_dwordx4 v8, s[28:31], s82 offen offset:0 lds
    s_waitcnt vmcnt(11)
    v_lshlrev_b32 v240, 16, v64
    v_and_b32 v241, 0xffff0000, v64
    v_lshlrev_b32 v242, 16, v65
    v_and_b32 v243, 0xffff0000, v65
    v_lshlrev_b32 v244, 16, v66
    v_and_b32 v245, 0xffff0000, v66
    v_lshlrev_b32 v246, 16, v67
    v_and_b32 v247, 0xffff0000, v67
    v_mul_f32 v240, s52, v240
    v_mul_f32 v241, s52, v241
    v_mul_f32 v242, s52, v242
    v_mul_f32 v243, s52, v243
    v_mul_f32 v244, s52, v244
    v_mul_f32 v245, s52, v245
    v_mul_f32 v246, s52, v246
    v_mul_f32 v247, s52, v247
    v_cvt_pk_bf16_f32 v64, v240, v241
    v_cvt_pk_bf16_f32 v65, v242, v243
    v_cvt_pk_bf16_f32 v66, v244, v245
    v_cvt_pk_bf16_f32 v67, v246, v247
    v_dot2c_f32_bf16 v255, v64, v64
    v_dot2c_f32_bf16 v255, v65, v65
    v_dot2c_f32_bf16 v255, v66, v66
    v_dot2c_f32_bf16 v255, v67, v67
    s_waitcnt lgkmcnt(0)
    v_mfma_f32_32x32x16_bf16 v[128:143], v[160:163], v[64:67], v[128:143]
    v_mfma_f32_32x32x16_bf16 v[144:159], v[164:167], v[64:67], v[144:159]
    s_add_u32 s82, s80, 6400
    s_add_u32 s83, s81, 8192
    s_mov_b32 m0, s83
    s_nop 0
    buffer_load_dwordx4 v8, s[28:31], s82 offen offset:0 lds
    s_waitcnt vmcnt(11)
    v_lshlrev_b32 v240, 16, v68
    v_and_b32 v241, 0xffff0000, v68
    v_lshlrev_b32 v242, 16, v69
    v_and_b32 v243, 0xffff0000, v69
    v_lshlrev_b32 v244, 16, v70
    v_and_b32 v245, 0xffff0000, v70
    v_lshlrev_b32 v246, 16, v71
    v_and_b32 v247, 0xffff0000, v71
    v_mul_f32 v240, s52, v240
    v_mul_f32 v241, s52, v241
    v_mul_f32 v242, s52, v242
    v_mul_f32 v243, s52, v243
    v_mul_f32 v244, s52, v244
    v_mul_f32 v245, s52, v245
    v_mul_f32 v246, s52, v246
    v_mul_f32 v247, s52, v247
    v_cvt_pk_bf16_f32 v68, v240, v241
    v_cvt_pk_bf16_f32 v69, v242, v243
    v_cvt_pk_bf16_f32 v70, v244, v245
    v_cvt_pk_bf16_f32 v71, v246, v247
    v_dot2c_f32_bf16 v255, v68, v68
    v_dot2c_f32_bf16 v255, v69, v69
    v_dot2c_f32_bf16 v255, v70, v70
    v_dot2c_f32_bf16 v255, v71, v71
    v_mfma_f32_32x32x16_bf16 v[128:143], v[168:171], v[68:71], v[128:143]
    v_mfma_f32_32x32x16_bf16 v[144:159], v[172:175], v[68:71], v[144:159]
    s_add_u32 s82, s80, 9216
    s_add_u32 s83, s81, 9216
    s_mov_b32 m0, s83
    s_nop 0
    buffer_load_dwordx4 v9, s[28:31], s82 offen offset:0 lds
    s_waitcnt vmcnt(11)
    v_lshlrev_b32 v240, 16, v72
    v_and_b32 v241, 0xffff0000, v72
    v_lshlrev_b32 v242, 16, v73
    v_and_b32 v243, 0xffff0000, v73
    v_lshlrev_b32 v244, 16, v74
    v_and_b32 v245, 0xffff0000, v74
    v_lshlrev_b32 v246, 16, v75
    v_and_b32 v247, 0xffff0000, v75
    v_mul_f32 v240, s52, v240
    v_mul_f32 v241, s52, v241
    v_mul_f32 v242, s52, v242
    v_mul_f32 v243, s52, v243
    v_mul_f32 v244, s52, v244
    v_mul_f32 v245, s52, v245
    v_mul_f32 v246, s52, v246
    v_mul_f32 v247, s52, v247
    v_cvt_pk_bf16_f32 v72, v240, v241
    v_cvt_pk_bf16_f32 v73, v242, v243
    v_cvt_pk_bf16_f32 v74, v244, v245
    v_cvt_pk_bf16_f32 v75, v246, v247
    v_dot2c_f32_bf16 v255, v72, v72
    v_dot2c_f32_bf16 v255, v73, v73
    v_dot2c_f32_bf16 v255, v74, v74
    v_dot2c_f32_bf16 v255, v75, v75
    v_mfma_f32_32x32x16_bf16 v[128:143], v[176:179], v[72:75], v[128:143]
    v_mfma_f32_32x32x16_bf16 v[144:159], v[180:183], v[72:75], v[144:159]
    s_add_u32 s82, s80, 9344
    s_add_u32 s83, s81, 10240
    s_mov_b32 m0, s83
    s_nop 0
    buffer_load_dwordx4 v9, s[28:31], s82 offen offset:0 lds
    s_waitcnt vmcnt(11)
    v_lshlrev_b32 v240, 16, v76
    v_and_b32 v241, 0xffff0000, v76
    v_lshlrev_b32 v242, 16, v77
    v_and_b32 v243, 0xffff0000, v77
    v_lshlrev_b32 v244, 16, v78
    v_and_b32 v245, 0xffff0000, v78
    v_lshlrev_b32 v246, 16, v79
    v_and_b32 v247, 0xffff0000, v79
    v_mul_f32 v240, s52, v240
    v_mul_f32 v241, s52, v241
    v_mul_f32 v242, s52, v242
    v_mul_f32 v243, s52, v243
    v_mul_f32 v244, s52, v244
    v_mul_f32 v245, s52, v245
    v_mul_f32 v246, s52, v246
    v_mul_f32 v247, s52, v247
    v_cvt_pk_bf16_f32 v76, v240, v241
    v_cvt_pk_bf16_f32 v77, v242, v243
    v_cvt_pk_bf16_f32 v78, v244, v245
    v_cvt_pk_bf16_f32 v79, v246, v247
    v_dot2c_f32_bf16 v255, v76, v76
    v_dot2c_f32_bf16 v255, v77, v77
    v_dot2c_f32_bf16 v255, v78, v78
    v_dot2c_f32_bf16 v255, v79, v79
    v_mfma_f32_32x32x16_bf16 v[128:143], v[184:187], v[76:79], v[128:143]
    v_mfma_f32_32x32x16_bf16 v[144:159], v[188:191], v[76:79], v[144:159]
    s_add_u32 s82, s80, 9472
    s_add_u32 s83, s81, 11264
    s_mov_b32 m0, s83
    s_nop 0
    buffer_load_dwordx4 v9, s[28:31], s82 offen offset:0 lds
    v_mov_b32 v240, v255
    v_mov_b32 v241, v255
    s_nop 1
    v_permlane32_swap_b32 v240, v241
    v_add_f32 v240, v240, v241
    v_cvt_pk_bf16_f32 v254, v240, v240
    v_lshlrev_b32 v254, 16, v254
    v_mul_f32 v254, 0.5, v254
    v_mov_b32 v253, s54
    v_cvt_pk_bf16_f32 v240, v128, v129
    v_cvt_pk_bf16_f32 v243, v130, v131
    v_lshlrev_b32 v241, 16, v240
    v_lshlrev_b32 v244, 16, v243
    v_and_b32 v240, 0xffff0000, v240
    v_and_b32 v243, 0xffff0000, v243
    v_sub_f32 v241, v241, v254
    v_sub_f32 v244, v244, v254
    v_sub_f32 v240, v240, v254
    v_sub_f32 v243, v243, v254
    v_cvt_pk_bf16_f32 v242, v241, v240
    v_cvt_pk_bf16_f32 v245, v244, v243
    v_lshlrev_b32 v241, 16, v242
    v_lshlrev_b32 v244, 16, v245
    v_and_b32 v240, 0xffff0000, v242
    v_and_b32 v243, 0xffff0000, v245
    v_mul_f32 v241, s53, v241
    v_mul_f32 v244, s53, v244
    v_mul_f32 v240, s53, v240
    v_mul_f32 v243, s53, v243
    v_exp_f32 v241, v241
    v_exp_f32 v244, v244
    v_exp_f32 v240, v240
    v_exp_f32 v243, v243
    v_cvt_pk_bf16_f32 v242, v241, v240
    v_cvt_pk_bf16_f32 v245, v244, v243
    v_lshlrev_b32 v241, 16, v242
    v_lshlrev_b32 v244, 16, v245
    v_and_b32 v240, 0xffff0000, v242
    v_and_b32 v243, 0xffff0000, v245
    v_fma_f32 v241, v241, s55, v253
    v_fma_f32 v244, v244, s55, v253
    v_fma_f32 v240, v240, s55, v253
    v_fma_f32 v243, v243, s55, v253
    v_cvt_pk_bf16_f32 v250, v241, v240
    v_cvt_pk_bf16_f32 v251, v244, v243
    ds_write_b64 v10, v[250:251] offset:0
    v_cvt_pk_bf16_f32 v240, v132, v133
    v_cvt_pk_bf16_f32 v243, v134, v135
    v_lshlrev_b32 v241, 16, v240
    v_lshlrev_b32 v244, 16, v243
    v_and_b32 v240, 0xffff0000, v240
    v_and_b32 v243, 0xffff0000, v243
    v_sub_f32 v241, v241, v254
    v_sub_f32 v244, v244, v254
    v_sub_f32 v240, v240, v254
    v_sub_f32 v243, v243, v254
    v_cvt_pk_bf16_f32 v242, v241, v240
    v_cvt_pk_bf16_f32 v245, v244, v243
    v_lshlrev_b32 v241, 16, v242
    v_lshlrev_b32 v244, 16, v245
    v_and_b32 v240, 0xffff0000, v242
    v_and_b32 v243, 0xffff0000, v245
    v_mul_f32 v241, s53, v241
    v_mul_f32 v244, s53, v244
    v_mul_f32 v240, s53, v240
    v_mul_f32 v243, s53, v243
    v_exp_f32 v241, v241
    v_exp_f32 v244, v244
    v_exp_f32 v240, v240
    v_exp_f32 v243, v243
    v_cvt_pk_bf16_f32 v242, v241, v240
    v_cvt_pk_bf16_f32 v245, v244, v243
    v_lshlrev_b32 v241, 16, v242
    v_lshlrev_b32 v244, 16, v245
    v_and_b32 v240, 0xffff0000, v242
    v_and_b32 v243, 0xffff0000, v245
    v_fma_f32 v241, v241, s55, v253
    v_fma_f32 v244, v244, s55, v253
    v_fma_f32 v240, v240, s55, v253
    v_fma_f32 v243, v243, s55, v253
    v_cvt_pk_bf16_f32 v250, v241, v240
    v_cvt_pk_bf16_f32 v251, v244, v243
    ds_write_b64 v10, v[250:251] offset:16
    v_cvt_pk_bf16_f32 v240, v136, v137
    v_cvt_pk_bf16_f32 v243, v138, v139
    v_lshlrev_b32 v241, 16, v240
    v_lshlrev_b32 v244, 16, v243
    v_and_b32 v240, 0xffff0000, v240
    v_and_b32 v243, 0xffff0000, v243
    v_sub_f32 v241, v241, v254
    v_sub_f32 v244, v244, v254
    v_sub_f32 v240, v240, v254
    v_sub_f32 v243, v243, v254
    v_cvt_pk_bf16_f32 v242, v241, v240
    v_cvt_pk_bf16_f32 v245, v244, v243
    v_lshlrev_b32 v241, 16, v242
    v_lshlrev_b32 v244, 16, v245
    v_and_b32 v240, 0xffff0000, v242
    v_and_b32 v243, 0xffff0000, v245
    v_mul_f32 v241, s53, v241
    v_mul_f32 v244, s53, v244
    v_mul_f32 v240, s53, v240
    v_mul_f32 v243, s53, v243
    v_exp_f32 v241, v241
    v_exp_f32 v244, v244
    v_exp_f32 v240, v240
    v_exp_f32 v243, v243
    v_cvt_pk_bf16_f32 v242, v241, v240
    v_cvt_pk_bf16_f32 v245, v244, v243
    v_lshlrev_b32 v241, 16, v242
    v_lshlrev_b32 v244, 16, v245
    v_and_b32 v240, 0xffff0000, v242
    v_and_b32 v243, 0xffff0000, v245
    v_fma_f32 v241, v241, s55, v253
    v_fma_f32 v244, v244, s55, v253
    v_fma_f32 v240, v240, s55, v253
    v_fma_f32 v243, v243, s55, v253
    v_cvt_pk_bf16_f32 v250, v241, v240
    v_cvt_pk_bf16_f32 v251, v244, v243
    ds_write_b64 v10, v[250:251] offset:32
    v_cvt_pk_bf16_f32 v240, v140, v141
    v_cvt_pk_bf16_f32 v243, v142, v143
    v_lshlrev_b32 v241, 16, v240
    v_lshlrev_b32 v244, 16, v243
    v_and_b32 v240, 0xffff0000, v240
    v_and_b32 v243, 0xffff0000, v243
    v_sub_f32 v241, v241, v254
    v_sub_f32 v244, v244, v254
    v_sub_f32 v240, v240, v254
    v_sub_f32 v243, v243, v254
    v_cvt_pk_bf16_f32 v242, v241, v240
    v_cvt_pk_bf16_f32 v245, v244, v243
    v_lshlrev_b32 v241, 16, v242
    v_lshlrev_b32 v244, 16, v245
    v_and_b32 v240, 0xffff0000, v242
    v_and_b32 v243, 0xffff0000, v245
    v_mul_f32 v241, s53, v241
    v_mul_f32 v244, s53, v244
    v_mul_f32 v240, s53, v240
    v_mul_f32 v243, s53, v243
    v_exp_f32 v241, v241
    v_exp_f32 v244, v244
    v_exp_f32 v240, v240
    v_exp_f32 v243, v243
    v_cvt_pk_bf16_f32 v242, v241, v240
    v_cvt_pk_bf16_f32 v245, v244, v243
    v_lshlrev_b32 v241, 16, v242
    v_lshlrev_b32 v244, 16, v245
    v_and_b32 v240, 0xffff0000, v242
    v_and_b32 v243, 0xffff0000, v245
    v_fma_f32 v241, v241, s55, v253
    v_fma_f32 v244, v244, s55, v253
    v_fma_f32 v240, v240, s55, v253
    v_fma_f32 v243, v243, s55, v253
    v_cvt_pk_bf16_f32 v250, v241, v240
    v_cvt_pk_bf16_f32 v251, v244, v243
    ds_write_b64 v10, v[250:251] offset:48
    v_cvt_pk_bf16_f32 v240, v144, v145
    v_cvt_pk_bf16_f32 v243, v146, v147
    v_lshlrev_b32 v241, 16, v240
    v_lshlrev_b32 v244, 16, v243
    v_and_b32 v240, 0xffff0000, v240
    v_and_b32 v243, 0xffff0000, v243
    v_sub_f32 v241, v241, v254
    v_sub_f32 v244, v244, v254
    v_sub_f32 v240, v240, v254
    v_sub_f32 v243, v243, v254
    v_cvt_pk_bf16_f32 v242, v241, v240
    v_cvt_pk_bf16_f32 v245, v244, v243
    v_lshlrev_b32 v241, 16, v242
    v_lshlrev_b32 v244, 16, v245
    v_and_b32 v240, 0xffff0000, v242
    v_and_b32 v243, 0xffff0000, v245
    v_mul_f32 v241, s53, v241
    v_mul_f32 v244, s53, v244
    v_mul_f32 v240, s53, v240
    v_mul_f32 v243, s53, v243
    v_exp_f32 v241, v241
    v_exp_f32 v244, v244
    v_exp_f32 v240, v240
    v_exp_f32 v243, v243
    v_cvt_pk_bf16_f32 v242, v241, v240
    v_cvt_pk_bf16_f32 v245, v244, v243
    v_lshlrev_b32 v241, 16, v242
    v_lshlrev_b32 v244, 16, v245
    v_and_b32 v240, 0xffff0000, v242
    v_and_b32 v243, 0xffff0000, v245
    v_fma_f32 v241, v241, s55, v253
    v_fma_f32 v244, v244, s55, v253
    v_fma_f32 v240, v240, s55, v253
    v_fma_f32 v243, v243, s55, v253
    v_cvt_pk_bf16_f32 v250, v241, v240
    v_cvt_pk_bf16_f32 v251, v244, v243
    ds_write_b64 v10, v[250:251] offset:64
    v_cvt_pk_bf16_f32 v240, v148, v149
    v_cvt_pk_bf16_f32 v243, v150, v151
    v_lshlrev_b32 v241, 16, v240
    v_lshlrev_b32 v244, 16, v243
    v_and_b32 v240, 0xffff0000, v240
    v_and_b32 v243, 0xffff0000, v243
    v_sub_f32 v241, v241, v254
    v_sub_f32 v244, v244, v254
    v_sub_f32 v240, v240, v254
    v_sub_f32 v243, v243, v254
    v_cvt_pk_bf16_f32 v242, v241, v240
    v_cvt_pk_bf16_f32 v245, v244, v243
    v_lshlrev_b32 v241, 16, v242
    v_lshlrev_b32 v244, 16, v245
    v_and_b32 v240, 0xffff0000, v242
    v_and_b32 v243, 0xffff0000, v245
    v_mul_f32 v241, s53, v241
    v_mul_f32 v244, s53, v244
    v_mul_f32 v240, s53, v240
    v_mul_f32 v243, s53, v243
    v_exp_f32 v241, v241
    v_exp_f32 v244, v244
    v_exp_f32 v240, v240
    v_exp_f32 v243, v243
    v_cvt_pk_bf16_f32 v242, v241, v240
    v_cvt_pk_bf16_f32 v245, v244, v243
    v_lshlrev_b32 v241, 16, v242
    v_lshlrev_b32 v244, 16, v245
    v_and_b32 v240, 0xffff0000, v242
    v_and_b32 v243, 0xffff0000, v245
    v_fma_f32 v241, v241, s55, v253
    v_fma_f32 v244, v244, s55, v253
    v_fma_f32 v240, v240, s55, v253
    v_fma_f32 v243, v243, s55, v253
    v_cvt_pk_bf16_f32 v250, v241, v240
    v_cvt_pk_bf16_f32 v251, v244, v243
    ds_write_b64 v10, v[250:251] offset:80
    v_cvt_pk_bf16_f32 v240, v152, v153
    v_cvt_pk_bf16_f32 v243, v154, v155
    v_lshlrev_b32 v241, 16, v240
    v_lshlrev_b32 v244, 16, v243
    v_and_b32 v240, 0xffff0000, v240
    v_and_b32 v243, 0xffff0000, v243
    v_sub_f32 v241, v241, v254
    v_sub_f32 v244, v244, v254
    v_sub_f32 v240, v240, v254
    v_sub_f32 v243, v243, v254
    v_cvt_pk_bf16_f32 v242, v241, v240
    v_cvt_pk_bf16_f32 v245, v244, v243
    v_lshlrev_b32 v241, 16, v242
    v_lshlrev_b32 v244, 16, v245
    v_and_b32 v240, 0xffff0000, v242
    v_and_b32 v243, 0xffff0000, v245
    v_mul_f32 v241, s53, v241
    v_mul_f32 v244, s53, v244
    v_mul_f32 v240, s53, v240
    v_mul_f32 v243, s53, v243
    v_exp_f32 v241, v241
    v_exp_f32 v244, v244
    v_exp_f32 v240, v240
    v_exp_f32 v243, v243
    v_cvt_pk_bf16_f32 v242, v241, v240
    v_cvt_pk_bf16_f32 v245, v244, v243
    v_lshlrev_b32 v241, 16, v242
    v_lshlrev_b32 v244, 16, v245
    v_and_b32 v240, 0xffff0000, v242
    v_and_b32 v243, 0xffff0000, v245
    v_fma_f32 v241, v241, s55, v253
    v_fma_f32 v244, v244, s55, v253
    v_fma_f32 v240, v240, s55, v253
    v_fma_f32 v243, v243, s55, v253
    v_cvt_pk_bf16_f32 v250, v241, v240
    v_cvt_pk_bf16_f32 v251, v244, v243
    ds_write_b64 v10, v[250:251] offset:96
    v_cvt_pk_bf16_f32 v240, v156, v157
    v_cvt_pk_bf16_f32 v243, v158, v159
    v_lshlrev_b32 v241, 16, v240
    v_lshlrev_b32 v244, 16, v243
    v_and_b32 v240, 0xffff0000, v240
    v_and_b32 v243, 0xffff0000, v243
    v_sub_f32 v241, v241, v254
    v_sub_f32 v244, v244, v254
    v_sub_f32 v240, v240, v254
    v_sub_f32 v243, v243, v254
    v_cvt_pk_bf16_f32 v242, v241, v240
    v_cvt_pk_bf16_f32 v245, v244, v243
    v_lshlrev_b32 v241, 16, v242
    v_lshlrev_b32 v244, 16, v245
    v_and_b32 v240, 0xffff0000, v242
    v_and_b32 v243, 0xffff0000, v245
    v_mul_f32 v241, s53, v241
    v_mul_f32 v244, s53, v244
    v_mul_f32 v240, s53, v240
    v_mul_f32 v243, s53, v243
    v_exp_f32 v241, v241
    v_exp_f32 v244, v244
    v_exp_f32 v240, v240
    v_exp_f32 v243, v243
    v_cvt_pk_bf16_f32 v242, v241, v240
    v_cvt_pk_bf16_f32 v245, v244, v243
    v_lshlrev_b32 v241, 16, v242
    v_lshlrev_b32 v244, 16, v245
    v_and_b32 v240, 0xffff0000, v242
    v_and_b32 v243, 0xffff0000, v245
    v_fma_f32 v241, v241, s55, v253
    v_fma_f32 v244, v244, s55, v253
    v_fma_f32 v240, v240, s55, v253
    v_fma_f32 v243, v243, s55, v253
    v_cvt_pk_bf16_f32 v250, v241, v240
    v_cvt_pk_bf16_f32 v251, v244, v243
    ds_write_b64 v10, v[250:251] offset:112
    s_waitcnt vmcnt(0) lgkmcnt(0)
    s_barrier
    v_mov_b32 v200, 0x3f803f80
    v_mov_b32 v201, 0x3f803f80
    v_mov_b32 v202, 0x3f803f80
    v_mov_b32 v203, 0x3f803f80
    ds_read_b64_tr_b16 v[160:161], v11 offset:0
    ds_read_b64_tr_b16 v[162:163], v11 offset:544
    ds_read_b64_tr_b16 v[164:165], v11 offset:32
    ds_read_b64_tr_b16 v[166:167], v11 offset:576
    ds_read_b64_tr_b16 v[168:169], v12 offset:0
    ds_read_b64_tr_b16 v[170:171], v12 offset:512
    ds_read_b64_tr_b16 v[172:173], v14 offset:0
    ds_read_b64_tr_b16 v[174:175], v14 offset:512
    ds_read_b64_tr_b16 v[176:177], v16 offset:0
    ds_read_b64_tr_b16 v[178:179], v16 offset:512
    ds_read_b64_tr_b16 v[180:181], v11 offset:4352
    ds_read_b64_tr_b16 v[182:183], v11 offset:4896
    ds_read_b64_tr_b16 v[184:185], v11 offset:4384
    ds_read_b64_tr_b16 v[186:187], v11 offset:4928
    s_waitcnt lgkmcnt(4)
    v_mfma_f32_16x16x32_bf16 v[128:131], v[160:163], v[168:171], 0
    v_mfma_f32_16x16x32_bf16 v[132:135], v[160:163], v[172:175], 0
    v_mfma_f32_16x16x32_bf16 v[136:139], v[160:163], v[176:179], 0
    v_mfma_f32_16x16x32_bf16 v[140:143], v[164:167], v[168:171], 0
    v_mfma_f32_16x16x32_bf16 v[144:147], v[164:167], v[172:175], 0
    v_mfma_f32_16x16x32_bf16 v[148:151], v[164:167], v[176:179], 0
    ds_read_b64_tr_b16 v[188:189], v12 offset:12288
    ds_read_b64_tr_b16 v[190:191], v12 offset:12800
    ds_read_b64_tr_b16 v[192:193], v14 offset:12288
    ds_read_b64_tr_b16 v[194:195], v14 offset:12800
    ds_read_b64_tr_b16 v[196:197], v16 offset:12288
    ds_read_b64_tr_b16 v[198:199], v16 offset:12800
    s_cmp_lg_u32 s78, 0
    s_cbranch_scc1 L_zskip_0
    v_mfma_f32_16x16x32_bf16 v[152:155], v[160:163], v[200:203], 0
    v_mfma_f32_16x16x32_bf16 v[156:159], v[164:167], v[200:203], 0
L_zskip_0:
    ds_read_b64_tr_b16 v[160:161], v11 offset:8704
    ds_read_b64_tr_b16 v[162:163], v11 offset:9248
    ds_read_b64_tr_b16 v[164:165], v11 offset:8736
    ds_read_b64_tr_b16 v[166:167], v11 offset:9280
    s_waitcnt lgkmcnt(4)
    v_mfma_f32_16x16x32_bf16 v[128:131], v[180:183], v[188:191], v[128:131]
    v_mfma_f32_16x16x32_bf16 v[132:135], v[180:183], v[192:195], v[132:135]
    v_mfma_f32_16x16x32_bf16 v[136:139], v[180:183], v[196:199], v[136:139]
    v_mfma_f32_16x16x32_bf16 v[140:143], v[184:187], v[188:191], v[140:143]
    v_mfma_f32_16x16x32_bf16 v[144:147], v[184:187], v[192:195], v[144:147]
    v_mfma_f32_16x16x32_bf16 v[148:151], v[184:187], v[196:199], v[148:151]
    ds_read_b64_tr_b16 v[168:169], v12 offset:24576
    ds_read_b64_tr_b16 v[170:171], v12 offset:25088
    ds_read_b64_tr_b16 v[172:173], v14 offset:24576
    ds_read_b64_tr_b16 v[174:175], v14 offset:25088
    ds_read_b64_tr_b16 v[176:177], v16 offset:24576
    ds_read_b64_tr_b16 v[178:179], v16 offset:25088
    s_cmp_lg_u32 s78, 0
    s_cbranch_scc1 L_zskip_1
    v_mfma_f32_16x16x32_bf16 v[152:155], v[180:183], v[200:203], v[152:155]
    v_mfma_f32_16x16x32_bf16 v[156:159], v[184:187], v[200:203], v[156:159]
L_zskip_1:
    ds_read_b64_tr_b16 v[180:181], v11 offset:13056
    ds_read_b64_tr_b16 v[182:183], v11 offset:13600
    ds_read_b64_tr_b16 v[184:185], v11 offset:13088
    ds_read_b64_tr_b16 v[186:187], v11 offset:13632
    s_waitcnt lgkmcnt(4)
    v_mfma_f32_16x16x32_bf16 v[128:131], v[160:163], v[168:171], v[128:131]
    v_mfma_f32_16x16x32_bf16 v[132:135], v[160:163], v[172:175], v[132:135]
    v_mfma_f32_16x16x32_bf16 v[136:139], v[160:163], v[176:179], v[136:139]
    v_mfma_f32_16x16x32_bf16 v[140:143], v[164:167], v[168:171], v[140:143]
    v_mfma_f32_16x16x32_bf16 v[144:147], v[164:167], v[172:175], v[144:147]
    v_mfma_f32_16x16x32_bf16 v[148:151], v[164:167], v[176:179], v[148:151]
    ds_read_b64_tr_b16 v[188:189], v12 offset:36864
    ds_read_b64_tr_b16 v[190:191], v12 offset:37376
    ds_read_b64_tr_b16 v[192:193], v14 offset:36864
    ds_read_b64_tr_b16 v[194:195], v14 offset:37376
    ds_read_b64_tr_b16 v[196:197], v16 offset:36864
    ds_read_b64_tr_b16 v[198:199], v16 offset:37376
    s_cmp_lg_u32 s78, 0
    s_cbranch_scc1 L_zskip_2
    v_mfma_f32_16x16x32_bf16 v[152:155], v[160:163], v[200:203], v[152:155]
    v_mfma_f32_16x16x32_bf16 v[156:159], v[164:167], v[200:203], v[156:159]
L_zskip_2:
    ds_read_b64_tr_b16 v[160:161], v11 offset:17408
    ds_read_b64_tr_b16 v[162:163], v11 offset:17952
    ds_read_b64_tr_b16 v[164:165], v11 offset:17440
    ds_read_b64_tr_b16 v[166:167], v11 offset:17984
    s_waitcnt lgkmcnt(4)
    v_mfma_f32_16x16x32_bf16 v[128:131], v[180:183], v[188:191], v[128:131]
    v_mfma_f32_16x16x32_bf16 v[132:135], v[180:183], v[192:195], v[132:135]
    v_mfma_f32_16x16x32_bf16 v[136:139], v[180:183], v[196:199], v[136:139]
    v_mfma_f32_16x16x32_bf16 v[140:143], v[184:187], v[188:191], v[140:143]
    v_mfma_f32_16x16x32_bf16 v[144:147], v[184:187], v[192:195], v[144:147]
    v_mfma_f32_16x16x32_bf16 v[148:151], v[184:187], v[196:199], v[148:151]
    ds_read_b64_tr_b16 v[168:169], v13 offset:0
    ds_read_b64_tr_b16 v[170:171], v13 offset:512
    ds_read_b64_tr_b16 v[172:173], v15 offset:0
    ds_read_b64_tr_b16 v[174:175], v15 offset:512
    ds_read_b64_tr_b16 v[176:177], v17 offset:0
    ds_read_b64_tr_b16 v[178:179], v17 offset:512
    s_cmp_lg_u32 s78, 0
    s_cbranch_scc1 L_zskip_3
    v_mfma_f32_16x16x32_bf16 v[152:155], v[180:183], v[200:203], v[152:155]
    v_mfma_f32_16x16x32_bf16 v[156:159], v[184:187], v[200:203], v[156:159]
L_zskip_3:
    ds_read_b64_tr_b16 v[180:181], v11 offset:21760
    ds_read_b64_tr_b16 v[182:183], v11 offset:22304
    ds_read_b64_tr_b16 v[184:185], v11 offset:21792
    ds_read_b64_tr_b16 v[186:187], v11 offset:22336
    s_waitcnt lgkmcnt(4)
    v_mfma_f32_16x16x32_bf16 v[128:131], v[160:163], v[168:171], v[128:131]
    v_mfma_f32_16x16x32_bf16 v[132:135], v[160:163], v[172:175], v[132:135]
    v_mfma_f32_16x16x32_bf16 v[136:139], v[160:163], v[176:179], v[136:139]
    v_mfma_f32_16x16x32_bf16 v[140:143], v[164:167], v[168:171], v[140:143]
    v_mfma_f32_16x16x32_bf16 v[144:147], v[164:167], v[172:175], v[144:147]
    v_mfma_f32_16x16x32_bf16 v[148:151], v[164:167], v[176:179], v[148:151]
    ds_read_b64_tr_b16 v[188:189], v13 offset:12288
    ds_read_b64_tr_b16 v[190:191], v13 offset:12800
    ds_read_b64_tr_b16 v[192:193], v15 offset:12288
    ds_read_b64_tr_b16 v[194:195], v15 offset:12800
    ds_read_b64_tr_b16 v[196:197], v17 offset:12288
    ds_read_b64_tr_b16 v[198:199], v17 offset:12800
    s_cmp_lg_u32 s78, 0
    s_cbranch_scc1 L_zskip_4
    v_mfma_f32_16x16x32_bf16 v[152:155], v[160:163], v[200:203], v[152:155]
    v_mfma_f32_16x16x32_bf16 v[156:159], v[164:167], v[200:203], v[156:159]
L_zskip_4:
    ds_read_b64_tr_b16 v[160:161], v11 offset:26112
    ds_read_b64_tr_b16 v[162:163], v11 offset:26656
    ds_read_b64_tr_b16 v[164:165], v11 offset:26144
    ds_read_b64_tr_b16 v[166:167], v11 offset:26688
    s_waitcnt lgkmcnt(4)
    v_mfma_f32_16x16x32_bf16 v[128:131], v[180:183], v[188:191], v[128:131]
    v_mfma_f32_16x16x32_bf16 v[132:135], v[180:183], v[192:195], v[132:135]
    v_mfma_f32_16x16x32_bf16 v[136:139], v[180:183], v[196:199], v[136:139]
    v_mfma_f32_16x16x32_bf16 v[140:143], v[184:187], v[188:191], v[140:143]
    v_mfma_f32_16x16x32_bf16 v[144:147], v[184:187], v[192:195], v[144:147]
    v_mfma_f32_16x16x32_bf16 v[148:151], v[184:187], v[196:199], v[148:151]
    ds_read_b64_tr_b16 v[168:169], v13 offset:24576
    ds_read_b64_tr_b16 v[170:171], v13 offset:25088
    ds_read_b64_tr_b16 v[172:173], v15 offset:24576
    ds_read_b64_tr_b16 v[174:175], v15 offset:25088
    ds_read_b64_tr_b16 v[176:177], v17 offset:24576
    ds_read_b64_tr_b16 v[178:179], v17 offset:25088
    s_cmp_lg_u32 s78, 0
    s_cbranch_scc1 L_zskip_5
    v_mfma_f32_16x16x32_bf16 v[152:155], v[180:183], v[200:203], v[152:155]
    v_mfma_f32_16x16x32_bf16 v[156:159], v[184:187], v[200:203], v[156:159]
L_zskip_5:
    ds_read_b64_tr_b16 v[180:181], v11 offset:30464
    ds_read_b64_tr_b16 v[182:183], v11 offset:31008
    ds_read_b64_tr_b16 v[184:185], v11 offset:30496
    ds_read_b64_tr_b16 v[186:187], v11 offset:31040
    s_waitcnt lgkmcnt(4)
    v_mfma_f32_16x16x32_bf16 v[128:131], v[160:163], v[168:171], v[128:131]
    v_mfma_f32_16x16x32_bf16 v[132:135], v[160:163], v[172:175], v[132:135]
    v_mfma_f32_16x16x32_bf16 v[136:139], v[160:163], v[176:179], v[136:139]
    v_mfma_f32_16x16x32_bf16 v[140:143], v[164:167], v[168:171], v[140:143]
    v_mfma_f32_16x16x32_bf16 v[144:147], v[164:167], v[172:175], v[144:147]
    v_mfma_f32_16x16x32_bf16 v[148:151], v[164:167], v[176:179], v[148:151]
    ds_read_b64_tr_b16 v[188:189], v13 offset:36864
    ds_read_b64_tr_b16 v[190:191], v13 offset:37376
    ds_read_b64_tr_b16 v[192:193], v15 offset:36864
    ds_read_b64_tr_b16 v[194:195], v15 offset:37376
    ds_read_b64_tr_b16 v[196:197], v17 offset:36864
    ds_read_b64_tr_b16 v[198:199], v17 offset:37376
    s_cmp_lg_u32 s78, 0
    s_cbranch_scc1 L_zskip_6
    v_mfma_f32_16x16x32_bf16 v[152:155], v[160:163], v[200:203], v[152:155]
    v_mfma_f32_16x16x32_bf16 v[156:159], v[164:167], v[200:203], v[156:159]
L_zskip_6:
    s_waitcnt lgkmcnt(0)
    v_mfma_f32_16x16x32_bf16 v[128:131], v[180:183], v[188:191], v[128:131]
    v_mfma_f32_16x16x32_bf16 v[132:135], v[180:183], v[192:195], v[132:135]
    v_mfma_f32_16x16x32_bf16 v[136:139], v[180:183], v[196:199], v[136:139]
    v_mfma_f32_16x16x32_bf16 v[140:143], v[184:187], v[188:191], v[140:143]
    v_mfma_f32_16x16x32_bf16 v[144:147], v[184:187], v[192:195], v[144:147]
    v_mfma_f32_16x16x32_bf16 v[148:151], v[184:187], v[196:199], v[148:151]
    s_cmp_lg_u32 s78, 0
    s_cbranch_scc1 L_zskip_7
    v_mfma_f32_16x16x32_bf16 v[152:155], v[180:183], v[200:203], v[152:155]
    v_mfma_f32_16x16x32_bf16 v[156:159], v[184:187], v[200:203], v[156:159]
L_zskip_7:
    s_lshl_b32 s60, s49, 3
    s_add_u32 s60, s60, s51
    s_mul_i32 s75, s60, 49152
    s_lshl_b32 s76, s60, 8
    s_add_u32 s76, s76, 12582912
    s_lshl_b32 s60, s77, 12
    s_add_u32 s60, s60, s75
    s_mul_i32 s61, s78, 3
    s_add_u32 s61, s61, 0
    s_lshr_b32 s62, s61, 1
    s_lshl_b32 s62, s62, 13
    s_and_b32 s61, s61, 1
    s_lshl_b32 s61, s61, 8
    s_add_u32 s61, s61, s62
    s_add_u32 s61, s61, s60
    buffer_store_dwordx4 v[128:131], v18, s[44:47], s61 offen offset:0
    buffer_store_dwordx4 v[140:143], v18, s[44:47], s61 offen offset:2048
    s_mul_i32 s61, s78, 3
    s_add_u32 s61, s61, 1
    s_lshr_b32 s62, s61, 1
    s_lshl_b32 s62, s62, 13
    s_and_b32 s61, s61, 1
    s_lshl_b32 s61, s61, 8
    s_add_u32 s61, s61, s62
    s_add_u32 s61, s61, s60
    buffer_store_dwordx4 v[132:135], v18, s[44:47], s61 offen offset:0
    buffer_store_dwordx4 v[144:147], v18, s[44:47], s61 offen offset:2048
    s_mul_i32 s61, s78, 3
    s_add_u32 s61, s61, 2
    s_lshr_b32 s62, s61, 1
    s_lshl_b32 s62, s62, 13
    s_and_b32 s61, s61, 1
    s_lshl_b32 s61, s61, 8
    s_add_u32 s61, s61, s62
    s_add_u32 s61, s61, s60
    buffer_store_dwordx4 v[136:139], v18, s[44:47], s61 offen offset:0
    buffer_store_dwordx4 v[148:151], v18, s[44:47], s61 offen offset:2048
    s_cmp_lg_u32 s78, 0
    s_cbranch_scc1 L_zst_skip
    v_lshlrev_b32 v22, 4, v4
    s_lshl_b32 s60, s77, 7
    s_add_u32 s60, s60, s76
    s_mov_b32 exec_lo, 0x00010001
    s_mov_b32 exec_hi, 0x00010001
    buffer_store_dwordx4 v[152:155], v22, s[44:47], s60 offen offset:0
    buffer_store_dwordx4 v[156:159], v22, s[44:47], s60 offen offset:64
    s_mov_b64 exec, -1
L_zst_skip:
    s_endpgm
.p2align 8
.globl rfa_output_kernel
.type rfa_output_kernel,@function
rfa_output_kernel:
    s_cmp_ge_u32 s2, 256
    s_cbranch_scc1 L_exit
    s_load_dwordx8 s[4:11], s[0:1], 0
    s_load_dwordx4 s[12:15], s[0:1], 32
    s_load_dwordx2 s[16:17], s[0:1], 48
    v_lshrrev_b32 v22, 6, v0
    s_nop 0
    v_readfirstlane_b32 s48, v22
    v_and_b32 v0, 63, v0
    s_and_b32 s60, s2, 7
    s_lshr_b32 s61, s2, 3
    s_and_b32 s61, s61, 3
    s_lshr_b32 s50, s2, 5
    s_lshl_b32 s60, s60, 2
    s_add_u32 s49, s60, s61
    s_mov_b32 s51, s50
    s_mov_b32 s72, 0
    s_mov_b32 s73, 0
    s_mov_b32 s74, 0
    s_mov_b32 s52, 0x3e898b82
    s_mov_b32 s53, 0x3fb8aa3b
    s_mov_b32 s54, 0x358637bd
    s_mov_b32 s55, 0x3e000000
    v_and_b32 v1, 31, v0
    v_lshrrev_b32 v2, 5, v0
    v_and_b32 v3, 15, v0
    v_lshrrev_b32 v4, 4, v0
    v_lshrrev_b32 v5, 2, v3
    v_and_b32 v6, 3, v3
    v_mov_b32 v21, 0
    v_lshlrev_b32 v19, 4, v0
    s_and_b32 s77, s48, 1
    s_lshr_b32 s78, s48, 1
    s_waitcnt lgkmcnt(0)
    s_mov_b32 s20, s4
    s_and_b32 s21, s5, 0xffff
    s_mov_b32 s22, 0x1800000
    s_mov_b32 s23, 0x00020000
    s_mov_b32 s24, s6
    s_and_b32 s25, s7, 0xffff
    s_mov_b32 s26, 0x1800000
    s_mov_b32 s27, 0x00020000
    s_mov_b32 s28, s8
    s_and_b32 s29, s9, 0xffff
    s_mov_b32 s30, 0x1800000
    s_mov_b32 s31, 0x00020000
    s_mov_b32 s32, s10
    s_and_b32 s33, s11, 0xffff
    s_mov_b32 s34, 0x6000
    s_mov_b32 s35, 0x00020000
    s_mov_b32 s36, s12
    s_and_b32 s37, s13, 0xffff
    s_mov_b32 s38, 0x1800000
    s_mov_b32 s39, 0x00020000
    s_mov_b32 s40, s14
    s_and_b32 s41, s15, 0xffff
    s_mov_b32 s42, 0x100
    s_mov_b32 s43, 0x00020000
    s_mov_b32 s44, s16
    s_and_b32 s45, s17, 0xffff
    s_mov_b32 s46, 0x10000000
    s_mov_b32 s47, 0x00020000
    s_mul_i32 s60, s49, 786432
    s_mul_i32 s61, s50, 98304
    s_add_u32 s56, s60, s61
    s_mov_b32 s57, s56
    s_mov_b32 s62, 384
    v_lshlrev_b32 v23, 5, v2
    v_mad_u32_u24 v7, s62, v1, v23
    v_lshrrev_b32 v22, 3, v0
    v_and_b32 v23, 7, v0
    v_lshrrev_b32 v24, 1, v23
    v_and_b32 v23, 1, v23
    v_lshrrev_b32 v25, 1, v22
    v_and_b32 v25, 1, v25
    v_xor_b32 v26, v24, v25
    v_lshlrev_b32 v26, 5, v26
    v_lshlrev_b32 v23, 4, v23
    v_mul_u32_u24 v22, s62, v22
    v_add3_u32 v8, v22, v23, v26
    v_xor_b32 v26, 64, v26
    v_add3_u32 v9, v22, v23, v26
    s_mul_i32 s63, s48, 4352
    s_add_u32 s63, s63, 122880
    s_mov_b32 s64, 136
    v_lshlrev_b32 v22, 3, v2
    v_mad_u32_u24 v22, s64, v1, v22
    v_add_u32 v10, s63, v22
    s_lshl_b32 s65, s77, 6
    s_add_u32 s65, s65, 122880
    v_lshl_add_u32 v22, v4, 3, v5
    v_mul_u32_u24 v22, s64, v22
    v_lshl_add_u32 v22, v6, 3, v22
    v_add_u32 v11, s65, v22
    v_lshlrev_b32 v22, 7, v5
    v_lshl_add_u32 v22, v6, 3, v22
    s_mov_b32 s66, 3072
    v_mad_u32_u24 v22, s66, v4, v22
    v_lshrrev_b32 v23, 1, v5
    v_and_b32 v23, 1, v23
    v_and_b32 v24, 1, v4
    v_lshl_add_u32 v23, v24, 1, v23
    v_lshl_add_u32 v22, v23, 5, v22
    v_add_u32 v22, 24576, v22
    s_mul_i32 s67, s78, 3
    s_add_u32 s67, s67, 0
    s_and_b32 s68, s67, 3
    s_lshl_b32 s68, s68, 5
    s_lshr_b32 s67, s67, 2
    s_lshl_b32 s67, s67, 10
    v_xor_b32 v23, s68, v22
    v_add_u32 v12, s67, v23
    s_add_u32 s67, s67, 49152
    v_add_u32 v13, s67, v23
    s_mul_i32 s67, s78, 3
    s_add_u32 s67, s67, 1
    s_and_b32 s68, s67, 3
    s_lshl_b32 s68, s68, 5
    s_lshr_b32 s67, s67, 2
    s_lshl_b32 s67, s67, 10
    v_xor_b32 v23, s68, v22
    v_add_u32 v14, s67, v23
    s_add_u32 s67, s67, 49152
    v_add_u32 v15, s67, v23
    s_mul_i32 s67, s78, 3
    s_add_u32 s67, s67, 2
    s_and_b32 s68, s67, 3
    s_lshl_b32 s68, s68, 5
    s_lshr_b32 s67, s67, 2
    s_lshl_b32 s67, s67, 10
    v_xor_b32 v23, s68, v22
    v_add_u32 v16, s67, v23
    s_add_u32 s67, s67, 49152
    v_add_u32 v17, s67, v23
    v_lshrrev_b32 v22, 1, v4
    v_lshlrev_b32 v22, 10, v22
    v_and_b32 v23, 1, v4
    v_lshl_or_b32 v22, v23, 9, v22
    v_lshl_add_u32 v18, v3, 4, v22
    v_lshlrev_b32 v22, 3, v2
    v_add_u32 v20, 49152, v22
    s_mul_i32 s60, s48, 12800
    s_add_u32 s60, s60, 50176
    s_mov_b32 s61, 384
    v_lshrrev_b32 v22, 3, v0
    v_and_b32 v23, 7, v0
    v_lshrrev_b32 v24, 1, v22
    v_xor_b32 v23, v23, v24
    v_lshlrev_b32 v23, 4, v23
    v_mul_u32_u24 v22, s61, v22
    v_add_u32 v8, v22, v23
    v_xor_b32 v23, 64, v23
    v_add_u32 v9, v22, v23
    v_lshrrev_b32 v22, 3, v1
    v_and_b32 v23, 7, v1
    v_lshrrev_b32 v24, 1, v23
    v_and_b32 v25, 1, v22
    v_lshl_add_u32 v24, v25, 2, v24
    v_lshlrev_b32 v25, 1, v2
    v_xor_b32 v24, v24, v25
    v_lshlrev_b32 v24, 4, v24
    v_lshl_add_u32 v24, v23, 7, v24
    s_mov_b32 s62, 3072
    v_mad_u32_u24 v24, s62, v22, v24
    v_add_u32 v24, s60, v24
    v_xor_b32 v10, 0, v24
    v_xor_b32 v11, 16, v24
    v_xor_b32 v12, 64, v24
    v_xor_b32 v13, 80, v24
    s_mov_b32 s62, 400
    v_lshlrev_b32 v22, 3, v2
    v_mad_u32_u24 v22, s62, v1, v22
    v_add_u32 v14, s60, v22
    v_lshrrev_b32 v22, 3, v0
    v_and_b32 v23, 7, v0
    v_lshlrev_b32 v23, 4, v23
    v_mad_u32_u24 v24, s62, v22, v23
    v_add_u32 v15, s60, v24
    v_mad_u32_u24 v16, s61, v22, v23
    s_mul_i32 s80, s49, 393216
    s_mul_i32 s61, s48, 6144
    s_add_u32 s80, s80, s61
    s_mul_i32 s62, s48, 3072
    s_add_u32 s62, s62, 24576
    v_add_u32 v31, s62, v19
    s_and_b32 s60, s48, 3
    s_lshr_b32 s61, s48, 2
    s_mul_i32 s61, s61, 12288
    s_mul_i32 s62, s48, 3072
    s_mul_i32 s63, s60, 3
    s_add_u32 s63, s63, 0
    s_and_b32 s64, s63, 1
    s_lshl_b32 s64, s64, 4
    s_lshr_b32 s63, s63, 1
    s_lshl_b32 s63, s63, 6
    s_add_u32 s63, s63, s64
    s_add_u32 s63, s63, s61
    s_add_u32 s64, s62, 0
    s_mov_b32 m0, s64
    s_nop 0
    buffer_load_dwordx4 v7, s[32:35], s63 offen offset:0 lds
    s_mul_i32 s63, s60, 3
    s_add_u32 s63, s63, 1
    s_and_b32 s64, s63, 1
    s_lshl_b32 s64, s64, 4
    s_lshr_b32 s63, s63, 1
    s_lshl_b32 s63, s63, 6
    s_add_u32 s63, s63, s64
    s_add_u32 s63, s63, s61
    s_add_u32 s64, s62, 1024
    s_mov_b32 m0, s64
    s_nop 0
    buffer_load_dwordx4 v7, s[32:35], s63 offen offset:0 lds
    s_mul_i32 s63, s60, 3
    s_add_u32 s63, s63, 2
    s_and_b32 s64, s63, 1
    s_lshl_b32 s64, s64, 4
    s_lshr_b32 s63, s63, 1
    s_lshl_b32 s63, s63, 6
    s_add_u32 s63, s63, s64
    s_add_u32 s63, s63, s61
    s_add_u32 s64, s62, 2048
    s_mov_b32 m0, s64
    s_nop 0
    buffer_load_dwordx4 v7, s[32:35], s63 offen offset:0 lds
    s_mul_i32 s60, s48, 12288
    s_add_u32 s60, s60, s56
    s_mul_i32 s63, s48, 12800
    s_add_u32 s63, s63, 50176
    s_add_u32 s61, s60, 0
    s_add_u32 s62, s63, 0
    s_mov_b32 m0, s62
    s_nop 0
    buffer_load_dwordx4 v8, s[20:23], s61 offen offset:0 lds
    s_add_u32 s61, s60, 128
    s_add_u32 s62, s63, 1024
    s_mov_b32 m0, s62
    s_nop 0
    buffer_load_dwordx4 v8, s[20:23], s61 offen offset:0 lds
    s_add_u32 s61, s60, 256
    s_add_u32 s62, s63, 2048
    s_mov_b32 m0, s62
    s_nop 0
    buffer_load_dwordx4 v8, s[20:23], s61 offen offset:0 lds
    s_add_u32 s61, s60, 3072
    s_add_u32 s62, s63, 3072
    s_mov_b32 m0, s62
    s_nop 0
    buffer_load_dwordx4 v9, s[20:23], s61 offen offset:0 lds
    s_add_u32 s61, s60, 3200
    s_add_u32 s62, s63, 4096
    s_mov_b32 m0, s62
    s_nop 0
    buffer_load_dwordx4 v9, s[20:23], s61 offen offset:0 lds
    s_add_u32 s61, s60, 3328
    s_add_u32 s62, s63, 5120
    s_mov_b32 m0, s62
    s_nop 0
    buffer_load_dwordx4 v9, s[20:23], s61 offen offset:0 lds
    s_add_u32 s61, s60, 6144
    s_add_u32 s62, s63, 6144
    s_mov_b32 m0, s62
    s_nop 0
    buffer_load_dwordx4 v8, s[20:23], s61 offen offset:0 lds
    s_add_u32 s61, s60, 6272
    s_add_u32 s62, s63, 7168
    s_mov_b32 m0, s62
    s_nop 0
    buffer_load_dwordx4 v8, s[20:23], s61 offen offset:0 lds
    s_add_u32 s61, s60, 6400
    s_add_u32 s62, s63, 8192
    s_mov_b32 m0, s62
    s_nop 0
    buffer_load_dwordx4 v8, s[20:23], s61 offen offset:0 lds
    s_add_u32 s61, s60, 9216
    s_add_u32 s62, s63, 9216
    s_mov_b32 m0, s62
    s_nop 0
    buffer_load_dwordx4 v9, s[20:23], s61 offen offset:0 lds
    s_add_u32 s61, s60, 9344
    s_add_u32 s62, s63, 10240
    s_mov_b32 m0, s62
    s_nop 0
    buffer_load_dwordx4 v9, s[20:23], s61 offen offset:0 lds
    s_add_u32 s61, s60, 9472
    s_add_u32 s62, s63, 11264
    s_mov_b32 m0, s62
    s_nop 0
    buffer_load_dwordx4 v9, s[20:23], s61 offen offset:0 lds
    s_waitcnt vmcnt(12)
    s_barrier
    s_waitcnt vmcnt(0)
    ds_read_b128 v[32:35], v10 offset:0
    ds_read_b128 v[36:39], v11 offset:0
    ds_read_b128 v[40:43], v12 offset:0
    ds_read_b128 v[44:47], v13 offset:0
    ds_read_b128 v[48:51], v10 offset:1024
    ds_read_b128 v[52:55], v11 offset:1024
    ds_read_b128 v[56:59], v12 offset:1024
    ds_read_b128 v[60:63], v13 offset:1024
    ds_read_b128 v[64:67], v10 offset:2048
    ds_read_b128 v[68:71], v11 offset:2048
    ds_read_b128 v[72:75], v12 offset:2048
    ds_read_b128 v[76:79], v13 offset:2048
    s_waitcnt lgkmcnt(0)
    ds_read_b128 v[160:163], v19 offset:0
    ds_read_b128 v[164:167], v19 offset:12288
    ds_read_b128 v[168:171], v19 offset:1024
    ds_read_b128 v[172:175], v19 offset:13312
    ds_read_b128 v[176:179], v19 offset:2048
    ds_read_b128 v[180:183], v19 offset:14336
    ds_read_b128 v[184:187], v19 offset:3072
    ds_read_b128 v[188:191], v19 offset:15360
    v_mov_b32 v95, 0
    ds_read_b128 v[192:195], v19 offset:4096
    ds_read_b128 v[196:199], v19 offset:16384
    ds_read_b128 v[200:203], v19 offset:5120
    ds_read_b128 v[204:207], v19 offset:17408
    ds_read_b128 v[208:211], v19 offset:6144
    ds_read_b128 v[212:215], v19 offset:18432
    ds_read_b128 v[216:219], v19 offset:7168
    ds_read_b128 v[220:223], v19 offset:19456
    v_lshlrev_b32 v80, 16, v32
    v_and_b32 v81, 0xffff0000, v32
    v_lshlrev_b32 v82, 16, v33
    v_and_b32 v83, 0xffff0000, v33
    v_lshlrev_b32 v84, 16, v34
    v_and_b32 v85, 0xffff0000, v34
    v_lshlrev_b32 v86, 16, v35
    v_and_b32 v87, 0xffff0000, v35
    v_mul_f32 v80, s52, v80
    v_mul_f32 v81, s52, v81
    v_mul_f32 v82, s52, v82
    v_mul_f32 v83, s52, v83
    v_mul_f32 v84, s52, v84
    v_mul_f32 v85, s52, v85
    v_mul_f32 v86, s52, v86
    v_mul_f32 v87, s52, v87
    v_cvt_pk_bf16_f32 v32, v80, v81
    v_cvt_pk_bf16_f32 v33, v82, v83
    v_cvt_pk_bf16_f32 v34, v84, v85
    v_cvt_pk_bf16_f32 v35, v86, v87
    v_dot2c_f32_bf16 v95, v32, v32
    v_dot2c_f32_bf16 v95, v33, v33
    v_dot2c_f32_bf16 v95, v34, v34
    v_dot2c_f32_bf16 v95, v35, v35
    s_waitcnt lgkmcnt(8)
    v_mfma_f32_32x32x16_bf16 v[224:239], v[160:163], v[32:35], 0
    v_mfma_f32_32x32x16_bf16 v[240:255], v[164:167], v[32:35], 0
    s_add_u32 s81, s80, 0
    buffer_load_dwordx4 v[96:99], v19, s[44:47], s81 offen offset:0
    buffer_load_dwordx4 v[100:103], v19, s[44:47], s81 offen offset:1024
    s_add_u32 s81, s81, 49152
    buffer_load_dwordx4 v[104:107], v19, s[44:47], s81 offen offset:0
    buffer_load_dwordx4 v[108:111], v19, s[44:47], s81 offen offset:1024
    v_lshlrev_b32 v80, 16, v36
    v_and_b32 v81, 0xffff0000, v36
    v_lshlrev_b32 v82, 16, v37
    v_and_b32 v83, 0xffff0000, v37
    v_lshlrev_b32 v84, 16, v38
    v_and_b32 v85, 0xffff0000, v38
    v_lshlrev_b32 v86, 16, v39
    v_and_b32 v87, 0xffff0000, v39
    v_mul_f32 v80, s52, v80
    v_mul_f32 v81, s52, v81
    v_mul_f32 v82, s52, v82
    v_mul_f32 v83, s52, v83
    v_mul_f32 v84, s52, v84
    v_mul_f32 v85, s52, v85
    v_mul_f32 v86, s52, v86
    v_mul_f32 v87, s52, v87
    v_cvt_pk_bf16_f32 v36, v80, v81
    v_cvt_pk_bf16_f32 v37, v82, v83
    v_cvt_pk_bf16_f32 v38, v84, v85
    v_cvt_pk_bf16_f32 v39, v86, v87
    v_dot2c_f32_bf16 v95, v36, v36
    v_dot2c_f32_bf16 v95, v37, v37
    v_dot2c_f32_bf16 v95, v38, v38
    v_dot2c_f32_bf16 v95, v39, v39
    v_mfma_f32_32x32x16_bf16 v[224:239], v[168:171], v[36:39], v[224:239]
    v_mfma_f32_32x32x16_bf16 v[240:255], v[172:175], v[36:39], v[240:255]
    s_add_u32 s81, s81, 49152
    buffer_load_dwordx4 v[112:115], v19, s[44:47], s81 offen offset:0
    buffer_load_dwordx4 v[116:119], v19, s[44:47], s81 offen offset:1024
    s_add_u32 s81, s81, 49152
    buffer_load_dwordx4 v[120:123], v19, s[44:47], s81 offen offset:0
    buffer_load_dwordx4 v[124:127], v19, s[44:47], s81 offen offset:1024
    v_lshlrev_b32 v80, 16, v40
    v_and_b32 v81, 0xffff0000, v40
    v_lshlrev_b32 v82, 16, v41
    v_and_b32 v83, 0xffff0000, v41
    v_lshlrev_b32 v84, 16, v42
    v_and_b32 v85, 0xffff0000, v42
    v_lshlrev_b32 v86, 16, v43
    v_and_b32 v87, 0xffff0000, v43
    v_mul_f32 v80, s52, v80
    v_mul_f32 v81, s52, v81
    v_mul_f32 v82, s52, v82
    v_mul_f32 v83, s52, v83
    v_mul_f32 v84, s52, v84
    v_mul_f32 v85, s52, v85
    v_mul_f32 v86, s52, v86
    v_mul_f32 v87, s52, v87
    v_cvt_pk_bf16_f32 v40, v80, v81
    v_cvt_pk_bf16_f32 v41, v82, v83
    v_cvt_pk_bf16_f32 v42, v84, v85
    v_cvt_pk_bf16_f32 v43, v86, v87
    v_dot2c_f32_bf16 v95, v40, v40
    v_dot2c_f32_bf16 v95, v41, v41
    v_dot2c_f32_bf16 v95, v42, v42
    v_dot2c_f32_bf16 v95, v43, v43
    v_mfma_f32_32x32x16_bf16 v[224:239], v[176:179], v[40:43], v[224:239]
    v_mfma_f32_32x32x16_bf16 v[240:255], v[180:183], v[40:43], v[240:255]
    s_add_u32 s81, s81, 49152
    buffer_load_dwordx4 v[128:131], v19, s[44:47], s81 offen offset:0
    buffer_load_dwordx4 v[132:135], v19, s[44:47], s81 offen offset:1024
    s_add_u32 s81, s81, 49152
    buffer_load_dwordx4 v[136:139], v19, s[44:47], s81 offen offset:0
    buffer_load_dwordx4 v[140:143], v19, s[44:47], s81 offen offset:1024
    v_lshlrev_b32 v80, 16, v44
    v_and_b32 v81, 0xffff0000, v44
    v_lshlrev_b32 v82, 16, v45
    v_and_b32 v83, 0xffff0000, v45
    v_lshlrev_b32 v84, 16, v46
    v_and_b32 v85, 0xffff0000, v46
    v_lshlrev_b32 v86, 16, v47
    v_and_b32 v87, 0xffff0000, v47
    v_mul_f32 v80, s52, v80
    v_mul_f32 v81, s52, v81
    v_mul_f32 v82, s52, v82
    v_mul_f32 v83, s52, v83
    v_mul_f32 v84, s52, v84
    v_mul_f32 v85, s52, v85
    v_mul_f32 v86, s52, v86
    v_mul_f32 v87, s52, v87
    v_cvt_pk_bf16_f32 v44, v80, v81
    v_cvt_pk_bf16_f32 v45, v82, v83
    v_cvt_pk_bf16_f32 v46, v84, v85
    v_cvt_pk_bf16_f32 v47, v86, v87
    v_dot2c_f32_bf16 v95, v44, v44
    v_dot2c_f32_bf16 v95, v45, v45
    v_dot2c_f32_bf16 v95, v46, v46
    v_dot2c_f32_bf16 v95, v47, v47
    v_mfma_f32_32x32x16_bf16 v[224:239], v[184:187], v[44:47], v[224:239]
    v_mfma_f32_32x32x16_bf16 v[240:255], v[188:191], v[44:47], v[240:255]
    s_add_u32 s81, s81, 49152
    buffer_load_dwordx4 v[144:147], v19, s[44:47], s81 offen offset:0
    buffer_load_dwordx4 v[148:151], v19, s[44:47], s81 offen offset:1024
    s_add_u32 s81, s81, 49152
    buffer_load_dwordx4 v[152:155], v19, s[44:47], s81 offen offset:0
    buffer_load_dwordx4 v[156:159], v19, s[44:47], s81 offen offset:1024
    ds_read_b128 v[160:163], v19 offset:8192
    ds_read_b128 v[164:167], v19 offset:20480
    ds_read_b128 v[168:171], v19 offset:9216
    ds_read_b128 v[172:175], v19 offset:21504
    ds_read_b128 v[176:179], v19 offset:10240
    ds_read_b128 v[180:183], v19 offset:22528
    ds_read_b128 v[184:187], v19 offset:11264
    ds_read_b128 v[188:191], v19 offset:23552
    v_lshlrev_b32 v80, 16, v48
    v_and_b32 v81, 0xffff0000, v48
    v_lshlrev_b32 v82, 16, v49
    v_and_b32 v83, 0xffff0000, v49
    v_lshlrev_b32 v84, 16, v50
    v_and_b32 v85, 0xffff0000, v50
    v_lshlrev_b32 v86, 16, v51
    v_and_b32 v87, 0xffff0000, v51
    v_mul_f32 v80, s52, v80
    v_mul_f32 v81, s52, v81
    v_mul_f32 v82, s52, v82
    v_mul_f32 v83, s52, v83
    v_mul_f32 v84, s52, v84
    v_mul_f32 v85, s52, v85
    v_mul_f32 v86, s52, v86
    v_mul_f32 v87, s52, v87
    v_cvt_pk_bf16_f32 v48, v80, v81
    v_cvt_pk_bf16_f32 v49, v82, v83
    v_cvt_pk_bf16_f32 v50, v84, v85
    v_cvt_pk_bf16_f32 v51, v86, v87
    v_dot2c_f32_bf16 v95, v48, v48
    v_dot2c_f32_bf16 v95, v49, v49
    v_dot2c_f32_bf16 v95, v50, v50
    v_dot2c_f32_bf16 v95, v51, v51
    s_waitcnt lgkmcnt(8)
    v_mfma_f32_32x32x16_bf16 v[224:239], v[192:195], v[48:51], v[224:239]
    v_mfma_f32_32x32x16_bf16 v[240:255], v[196:199], v[48:51], v[240:255]
    v_lshlrev_b32 v80, 16, v52
    v_and_b32 v81, 0xffff0000, v52
    v_lshlrev_b32 v82, 16, v53
    v_and_b32 v83, 0xffff0000, v53
    v_lshlrev_b32 v84, 16, v54
    v_and_b32 v85, 0xffff0000, v54
    v_lshlrev_b32 v86, 16, v55
    v_and_b32 v87, 0xffff0000, v55
    v_mul_f32 v80, s52, v80
    v_mul_f32 v81, s52, v81
    v_mul_f32 v82, s52, v82
    v_mul_f32 v83, s52, v83
    v_mul_f32 v84, s52, v84
    v_mul_f32 v85, s52, v85
    v_mul_f32 v86, s52, v86
    v_mul_f32 v87, s52, v87
    v_cvt_pk_bf16_f32 v52, v80, v81
    v_cvt_pk_bf16_f32 v53, v82, v83
    v_cvt_pk_bf16_f32 v54, v84, v85
    v_cvt_pk_bf16_f32 v55, v86, v87
    v_dot2c_f32_bf16 v95, v52, v52
    v_dot2c_f32_bf16 v95, v53, v53
    v_dot2c_f32_bf16 v95, v54, v54
    v_dot2c_f32_bf16 v95, v55, v55
    v_mfma_f32_32x32x16_bf16 v[224:239], v[200:203], v[52:55], v[224:239]
    v_mfma_f32_32x32x16_bf16 v[240:255], v[204:207], v[52:55], v[240:255]
    v_lshlrev_b32 v80, 16, v56
    v_and_b32 v81, 0xffff0000, v56
    v_lshlrev_b32 v82, 16, v57
    v_and_b32 v83, 0xffff0000, v57
    v_lshlrev_b32 v84, 16, v58
    v_and_b32 v85, 0xffff0000, v58
    v_lshlrev_b32 v86, 16, v59
    v_and_b32 v87, 0xffff0000, v59
    v_mul_f32 v80, s52, v80
    v_mul_f32 v81, s52, v81
    v_mul_f32 v82, s52, v82
    v_mul_f32 v83, s52, v83
    v_mul_f32 v84, s52, v84
    v_mul_f32 v85, s52, v85
    v_mul_f32 v86, s52, v86
    v_mul_f32 v87, s52, v87
    v_cvt_pk_bf16_f32 v56, v80, v81
    v_cvt_pk_bf16_f32 v57, v82, v83
    v_cvt_pk_bf16_f32 v58, v84, v85
    v_cvt_pk_bf16_f32 v59, v86, v87
    v_dot2c_f32_bf16 v95, v56, v56
    v_dot2c_f32_bf16 v95, v57, v57
    v_dot2c_f32_bf16 v95, v58, v58
    v_dot2c_f32_bf16 v95, v59, v59
    v_mfma_f32_32x32x16_bf16 v[224:239], v[208:211], v[56:59], v[224:239]
    v_mfma_f32_32x32x16_bf16 v[240:255], v[212:215], v[56:59], v[240:255]
    v_lshlrev_b32 v80, 16, v60
    v_and_b32 v81, 0xffff0000, v60
    v_lshlrev_b32 v82, 16, v61
    v_and_b32 v83, 0xffff0000, v61
    v_lshlrev_b32 v84, 16, v62
    v_and_b32 v85, 0xffff0000, v62
    v_lshlrev_b32 v86, 16, v63
    v_and_b32 v87, 0xffff0000, v63
    v_mul_f32 v80, s52, v80
    v_mul_f32 v81, s52, v81
    v_mul_f32 v82, s52, v82
    v_mul_f32 v83, s52, v83
    v_mul_f32 v84, s52, v84
    v_mul_f32 v85, s52, v85
    v_mul_f32 v86, s52, v86
    v_mul_f32 v87, s52, v87
    v_cvt_pk_bf16_f32 v60, v80, v81
    v_cvt_pk_bf16_f32 v61, v82, v83
    v_cvt_pk_bf16_f32 v62, v84, v85
    v_cvt_pk_bf16_f32 v63, v86, v87
    v_dot2c_f32_bf16 v95, v60, v60
    v_dot2c_f32_bf16 v95, v61, v61
    v_dot2c_f32_bf16 v95, v62, v62
    v_dot2c_f32_bf16 v95, v63, v63
    v_mfma_f32_32x32x16_bf16 v[224:239], v[216:219], v[60:63], v[224:239]
    v_mfma_f32_32x32x16_bf16 v[240:255], v[220:223], v[60:63], v[240:255]
    v_lshlrev_b32 v80, 16, v64
    v_and_b32 v81, 0xffff0000, v64
    v_lshlrev_b32 v82, 16, v65
    v_and_b32 v83, 0xffff0000, v65
    v_lshlrev_b32 v84, 16, v66
    v_and_b32 v85, 0xffff0000, v66
    v_lshlrev_b32 v86, 16, v67
    v_and_b32 v87, 0xffff0000, v67
    v_mul_f32 v80, s52, v80
    v_mul_f32 v81, s52, v81
    v_mul_f32 v82, s52, v82
    v_mul_f32 v83, s52, v83
    v_mul_f32 v84, s52, v84
    v_mul_f32 v85, s52, v85
    v_mul_f32 v86, s52, v86
    v_mul_f32 v87, s52, v87
    v_cvt_pk_bf16_f32 v64, v80, v81
    v_cvt_pk_bf16_f32 v65, v82, v83
    v_cvt_pk_bf16_f32 v66, v84, v85
    v_cvt_pk_bf16_f32 v67, v86, v87
    v_dot2c_f32_bf16 v95, v64, v64
    v_dot2c_f32_bf16 v95, v65, v65
    v_dot2c_f32_bf16 v95, v66, v66
    v_dot2c_f32_bf16 v95, v67, v67
    s_waitcnt lgkmcnt(0)
    v_mfma_f32_32x32x16_bf16 v[224:239], v[160:163], v[64:67], v[224:239]
    v_mfma_f32_32x32x16_bf16 v[240:255], v[164:167], v[64:67], v[240:255]
    v_lshlrev_b32 v80, 16, v68
    v_and_b32 v81, 0xffff0000, v68
    v_lshlrev_b32 v82, 16, v69
    v_and_b32 v83, 0xffff0000, v69
    v_lshlrev_b32 v84, 16, v70
    v_and_b32 v85, 0xffff0000, v70
    v_lshlrev_b32 v86, 16, v71
    v_and_b32 v87, 0xffff0000, v71
    v_mul_f32 v80, s52, v80
    v_mul_f32 v81, s52, v81
    v_mul_f32 v82, s52, v82
    v_mul_f32 v83, s52, v83
    v_mul_f32 v84, s52, v84
    v_mul_f32 v85, s52, v85
    v_mul_f32 v86, s52, v86
    v_mul_f32 v87, s52, v87
    v_cvt_pk_bf16_f32 v68, v80, v81
    v_cvt_pk_bf16_f32 v69, v82, v83
    v_cvt_pk_bf16_f32 v70, v84, v85
    v_cvt_pk_bf16_f32 v71, v86, v87
    v_dot2c_f32_bf16 v95, v68, v68
    v_dot2c_f32_bf16 v95, v69, v69
    v_dot2c_f32_bf16 v95, v70, v70
    v_dot2c_f32_bf16 v95, v71, v71
    v_mfma_f32_32x32x16_bf16 v[224:239], v[168:171], v[68:71], v[224:239]
    v_mfma_f32_32x32x16_bf16 v[240:255], v[172:175], v[68:71], v[240:255]
    v_lshlrev_b32 v80, 16, v72
    v_and_b32 v81, 0xffff0000, v72
    v_lshlrev_b32 v82, 16, v73
    v_and_b32 v83, 0xffff0000, v73
    v_lshlrev_b32 v84, 16, v74
    v_and_b32 v85, 0xffff0000, v74
    v_lshlrev_b32 v86, 16, v75
    v_and_b32 v87, 0xffff0000, v75
    v_mul_f32 v80, s52, v80
    v_mul_f32 v81, s52, v81
    v_mul_f32 v82, s52, v82
    v_mul_f32 v83, s52, v83
    v_mul_f32 v84, s52, v84
    v_mul_f32 v85, s52, v85
    v_mul_f32 v86, s52, v86
    v_mul_f32 v87, s52, v87
    v_cvt_pk_bf16_f32 v72, v80, v81
    v_cvt_pk_bf16_f32 v73, v82, v83
    v_cvt_pk_bf16_f32 v74, v84, v85
    v_cvt_pk_bf16_f32 v75, v86, v87
    v_dot2c_f32_bf16 v95, v72, v72
    v_dot2c_f32_bf16 v95, v73, v73
    v_dot2c_f32_bf16 v95, v74, v74
    v_dot2c_f32_bf16 v95, v75, v75
    v_mfma_f32_32x32x16_bf16 v[224:239], v[176:179], v[72:75], v[224:239]
    v_mfma_f32_32x32x16_bf16 v[240:255], v[180:183], v[72:75], v[240:255]
    v_lshlrev_b32 v80, 16, v76
    v_and_b32 v81, 0xffff0000, v76
    v_lshlrev_b32 v82, 16, v77
    v_and_b32 v83, 0xffff0000, v77
    v_lshlrev_b32 v84, 16, v78
    v_and_b32 v85, 0xffff0000, v78
    v_lshlrev_b32 v86, 16, v79
    v_and_b32 v87, 0xffff0000, v79
    v_mul_f32 v80, s52, v80
    v_mul_f32 v81, s52, v81
    v_mul_f32 v82, s52, v82
    v_mul_f32 v83, s52, v83
    v_mul_f32 v84, s52, v84
    v_mul_f32 v85, s52, v85
    v_mul_f32 v86, s52, v86
    v_mul_f32 v87, s52, v87
    v_cvt_pk_bf16_f32 v76, v80, v81
    v_cvt_pk_bf16_f32 v77, v82, v83
    v_cvt_pk_bf16_f32 v78, v84, v85
    v_cvt_pk_bf16_f32 v79, v86, v87
    v_dot2c_f32_bf16 v95, v76, v76
    v_dot2c_f32_bf16 v95, v77, v77
    v_dot2c_f32_bf16 v95, v78, v78
    v_dot2c_f32_bf16 v95, v79, v79
    v_mfma_f32_32x32x16_bf16 v[224:239], v[184:187], v[76:79], v[224:239]
    v_mfma_f32_32x32x16_bf16 v[240:255], v[188:191], v[76:79], v[240:255]
    s_nop 0
    v_mov_b32 v80, v95
    v_mov_b32 v81, v95
    s_nop 1
    v_permlane32_swap_b32 v80, v81
    v_add_f32 v80, v80, v81
    v_cvt_pk_bf16_f32 v94, v80, v80
    v_lshlrev_b32 v94, 16, v94
    v_mul_f32 v94, 0.5, v94
    v_mov_b32 v93, s54
    v_cvt_pk_bf16_f32 v80, v224, v225
    v_cvt_pk_bf16_f32 v83, v226, v227
    v_lshlrev_b32 v81, 16, v80
    v_lshlrev_b32 v84, 16, v83
    v_and_b32 v80, 0xffff0000, v80
    v_and_b32 v83, 0xffff0000, v83
    v_sub_f32 v81, v81, v94
    v_sub_f32 v84, v84, v94
    v_sub_f32 v80, v80, v94
    v_sub_f32 v83, v83, v94
    v_cvt_pk_bf16_f32 v82, v81, v80
    v_cvt_pk_bf16_f32 v85, v84, v83
    v_lshlrev_b32 v81, 16, v82
    v_lshlrev_b32 v84, 16, v85
    v_and_b32 v80, 0xffff0000, v82
    v_and_b32 v83, 0xffff0000, v85
    v_mul_f32 v81, s53, v81
    v_mul_f32 v84, s53, v84
    v_mul_f32 v80, s53, v80
    v_mul_f32 v83, s53, v83
    v_exp_f32 v81, v81
    v_exp_f32 v84, v84
    v_exp_f32 v80, v80
    v_exp_f32 v83, v83
    v_cvt_pk_bf16_f32 v82, v81, v80
    v_cvt_pk_bf16_f32 v85, v84, v83
    v_lshlrev_b32 v81, 16, v82
    v_lshlrev_b32 v84, 16, v85
    v_and_b32 v80, 0xffff0000, v82
    v_and_b32 v83, 0xffff0000, v85
    v_fma_f32 v81, v81, s55, v93
    v_fma_f32 v84, v84, s55, v93
    v_fma_f32 v80, v80, s55, v93
    v_fma_f32 v83, v83, s55, v93
    v_cvt_pk_bf16_f32 v224, v81, v80
    v_cvt_pk_bf16_f32 v225, v84, v83
    s_add_u32 s81, s80, 2048
    buffer_load_dwordx4 v[160:163], v19, s[44:47], s81 offen offset:0
    buffer_load_dwordx4 v[164:167], v19, s[44:47], s81 offen offset:1024
    v_cvt_pk_bf16_f32 v80, v228, v229
    v_cvt_pk_bf16_f32 v83, v230, v231
    v_lshlrev_b32 v81, 16, v80
    v_lshlrev_b32 v84, 16, v83
    v_and_b32 v80, 0xffff0000, v80
    v_and_b32 v83, 0xffff0000, v83
    v_sub_f32 v81, v81, v94
    v_sub_f32 v84, v84, v94
    v_sub_f32 v80, v80, v94
    v_sub_f32 v83, v83, v94
    v_cvt_pk_bf16_f32 v82, v81, v80
    v_cvt_pk_bf16_f32 v85, v84, v83
    v_lshlrev_b32 v81, 16, v82
    v_lshlrev_b32 v84, 16, v85
    v_and_b32 v80, 0xffff0000, v82
    v_and_b32 v83, 0xffff0000, v85
    v_mul_f32 v81, s53, v81
    v_mul_f32 v84, s53, v84
    v_mul_f32 v80, s53, v80
    v_mul_f32 v83, s53, v83
    v_exp_f32 v81, v81
    v_exp_f32 v84, v84
    v_exp_f32 v80, v80
    v_exp_f32 v83, v83
    v_cvt_pk_bf16_f32 v82, v81, v80
    v_cvt_pk_bf16_f32 v85, v84, v83
    v_lshlrev_b32 v81, 16, v82
    v_lshlrev_b32 v84, 16, v85
    v_and_b32 v80, 0xffff0000, v82
    v_and_b32 v83, 0xffff0000, v85
    v_fma_f32 v81, v81, s55, v93
    v_fma_f32 v84, v84, s55, v93
    v_fma_f32 v80, v80, s55, v93
    v_fma_f32 v83, v83, s55, v93
    v_cvt_pk_bf16_f32 v226, v81, v80
    v_cvt_pk_bf16_f32 v227, v84, v83
    s_add_u32 s81, s81, 49152
    buffer_load_dwordx4 v[168:171], v19, s[44:47], s81 offen offset:0
    buffer_load_dwordx4 v[172:175], v19, s[44:47], s81 offen offset:1024
    v_cvt_pk_bf16_f32 v80, v232, v233
    v_cvt_pk_bf16_f32 v83, v234, v235
    v_lshlrev_b32 v81, 16, v80
    v_lshlrev_b32 v84, 16, v83
    v_and_b32 v80, 0xffff0000, v80
    v_and_b32 v83, 0xffff0000, v83
    v_sub_f32 v81, v81, v94
    v_sub_f32 v84, v84, v94
    v_sub_f32 v80, v80, v94
    v_sub_f32 v83, v83, v94
    v_cvt_pk_bf16_f32 v82, v81, v80
    v_cvt_pk_bf16_f32 v85, v84, v83
    v_lshlrev_b32 v81, 16, v82
    v_lshlrev_b32 v84, 16, v85
    v_and_b32 v80, 0xffff0000, v82
    v_and_b32 v83, 0xffff0000, v85
    v_mul_f32 v81, s53, v81
    v_mul_f32 v84, s53, v84
    v_mul_f32 v80, s53, v80
    v_mul_f32 v83, s53, v83
    v_exp_f32 v81, v81
    v_exp_f32 v84, v84
    v_exp_f32 v80, v80
    v_exp_f32 v83, v83
    v_cvt_pk_bf16_f32 v82, v81, v80
    v_cvt_pk_bf16_f32 v85, v84, v83
    v_lshlrev_b32 v81, 16, v82
    v_lshlrev_b32 v84, 16, v85
    v_and_b32 v80, 0xffff0000, v82
    v_and_b32 v83, 0xffff0000, v85
    v_fma_f32 v81, v81, s55, v93
    v_fma_f32 v84, v84, s55, v93
    v_fma_f32 v80, v80, s55, v93
    v_fma_f32 v83, v83, s55, v93
    v_cvt_pk_bf16_f32 v228, v81, v80
    v_cvt_pk_bf16_f32 v229, v84, v83
    s_add_u32 s81, s81, 49152
    buffer_load_dwordx4 v[176:179], v19, s[44:47], s81 offen offset:0
    buffer_load_dwordx4 v[180:183], v19, s[44:47], s81 offen offset:1024
    v_cvt_pk_bf16_f32 v80, v236, v237
    v_cvt_pk_bf16_f32 v83, v238, v239
    v_lshlrev_b32 v81, 16, v80
    v_lshlrev_b32 v84, 16, v83
    v_and_b32 v80, 0xffff0000, v80
    v_and_b32 v83, 0xffff0000, v83
    v_sub_f32 v81, v81, v94
    v_sub_f32 v84, v84, v94
    v_sub_f32 v80, v80, v94
    v_sub_f32 v83, v83, v94
    v_cvt_pk_bf16_f32 v82, v81, v80
    v_cvt_pk_bf16_f32 v85, v84, v83
    v_lshlrev_b32 v81, 16, v82
    v_lshlrev_b32 v84, 16, v85
    v_and_b32 v80, 0xffff0000, v82
    v_and_b32 v83, 0xffff0000, v85
    v_mul_f32 v81, s53, v81
    v_mul_f32 v84, s53, v84
    v_mul_f32 v80, s53, v80
    v_mul_f32 v83, s53, v83
    v_exp_f32 v81, v81
    v_exp_f32 v84, v84
    v_exp_f32 v80, v80
    v_exp_f32 v83, v83
    v_cvt_pk_bf16_f32 v82, v81, v80
    v_cvt_pk_bf16_f32 v85, v84, v83
    v_lshlrev_b32 v81, 16, v82
    v_lshlrev_b32 v84, 16, v85
    v_and_b32 v80, 0xffff0000, v82
    v_and_b32 v83, 0xffff0000, v85
    v_fma_f32 v81, v81, s55, v93
    v_fma_f32 v84, v84, s55, v93
    v_fma_f32 v80, v80, s55, v93
    v_fma_f32 v83, v83, s55, v93
    v_cvt_pk_bf16_f32 v230, v81, v80
    v_cvt_pk_bf16_f32 v231, v84, v83
    s_add_u32 s81, s81, 49152
    buffer_load_dwordx4 v[184:187], v19, s[44:47], s81 offen offset:0
    buffer_load_dwordx4 v[188:191], v19, s[44:47], s81 offen offset:1024
    v_cvt_pk_bf16_f32 v80, v240, v241
    v_cvt_pk_bf16_f32 v83, v242, v243
    v_lshlrev_b32 v81, 16, v80
    v_lshlrev_b32 v84, 16, v83
    v_and_b32 v80, 0xffff0000, v80
    v_and_b32 v83, 0xffff0000, v83
    v_sub_f32 v81, v81, v94
    v_sub_f32 v84, v84, v94
    v_sub_f32 v80, v80, v94
    v_sub_f32 v83, v83, v94
    v_cvt_pk_bf16_f32 v82, v81, v80
    v_cvt_pk_bf16_f32 v85, v84, v83
    v_lshlrev_b32 v81, 16, v82
    v_lshlrev_b32 v84, 16, v85
    v_and_b32 v80, 0xffff0000, v82
    v_and_b32 v83, 0xffff0000, v85
    v_mul_f32 v81, s53, v81
    v_mul_f32 v84, s53, v84
    v_mul_f32 v80, s53, v80
    v_mul_f32 v83, s53, v83
    v_exp_f32 v81, v81
    v_exp_f32 v84, v84
    v_exp_f32 v80, v80
    v_exp_f32 v83, v83
    v_cvt_pk_bf16_f32 v82, v81, v80
    v_cvt_pk_bf16_f32 v85, v84, v83
    v_lshlrev_b32 v81, 16, v82
    v_lshlrev_b32 v84, 16, v85
    v_and_b32 v80, 0xffff0000, v82
    v_and_b32 v83, 0xffff0000, v85
    v_fma_f32 v81, v81, s55, v93
    v_fma_f32 v84, v84, s55, v93
    v_fma_f32 v80, v80, s55, v93
    v_fma_f32 v83, v83, s55, v93
    v_cvt_pk_bf16_f32 v240, v81, v80
    v_cvt_pk_bf16_f32 v241, v84, v83
    s_add_u32 s81, s81, 49152
    buffer_load_dwordx4 v[192:195], v19, s[44:47], s81 offen offset:0
    buffer_load_dwordx4 v[196:199], v19, s[44:47], s81 offen offset:1024
    v_cvt_pk_bf16_f32 v80, v244, v245
    v_cvt_pk_bf16_f32 v83, v246, v247
    v_lshlrev_b32 v81, 16, v80
    v_lshlrev_b32 v84, 16, v83
    v_and_b32 v80, 0xffff0000, v80
    v_and_b32 v83, 0xffff0000, v83
    v_sub_f32 v81, v81, v94
    v_sub_f32 v84, v84, v94
    v_sub_f32 v80, v80, v94
    v_sub_f32 v83, v83, v94
    v_cvt_pk_bf16_f32 v82, v81, v80
    v_cvt_pk_bf16_f32 v85, v84, v83
    v_lshlrev_b32 v81, 16, v82
    v_lshlrev_b32 v84, 16, v85
    v_and_b32 v80, 0xffff0000, v82
    v_and_b32 v83, 0xffff0000, v85
    v_mul_f32 v81, s53, v81
    v_mul_f32 v84, s53, v84
    v_mul_f32 v80, s53, v80
    v_mul_f32 v83, s53, v83
    v_exp_f32 v81, v81
    v_exp_f32 v84, v84
    v_exp_f32 v80, v80
    v_exp_f32 v83, v83
    v_cvt_pk_bf16_f32 v82, v81, v80
    v_cvt_pk_bf16_f32 v85, v84, v83
    v_lshlrev_b32 v81, 16, v82
    v_lshlrev_b32 v84, 16, v85
    v_and_b32 v80, 0xffff0000, v82
    v_and_b32 v83, 0xffff0000, v85
    v_fma_f32 v81, v81, s55, v93
    v_fma_f32 v84, v84, s55, v93
    v_fma_f32 v80, v80, s55, v93
    v_fma_f32 v83, v83, s55, v93
    v_cvt_pk_bf16_f32 v242, v81, v80
    v_cvt_pk_bf16_f32 v243, v84, v83
    s_add_u32 s81, s81, 49152
    buffer_load_dwordx4 v[200:203], v19, s[44:47], s81 offen offset:0
    buffer_load_dwordx4 v[204:207], v19, s[44:47], s81 offen offset:1024
    v_cvt_pk_bf16_f32 v80, v248, v249
    v_cvt_pk_bf16_f32 v83, v250, v251
    v_lshlrev_b32 v81, 16, v80
    v_lshlrev_b32 v84, 16, v83
    v_and_b32 v80, 0xffff0000, v80
    v_and_b32 v83, 0xffff0000, v83
    v_sub_f32 v81, v81, v94
    v_sub_f32 v84, v84, v94
    v_sub_f32 v80, v80, v94
    v_sub_f32 v83, v83, v94
    v_cvt_pk_bf16_f32 v82, v81, v80
    v_cvt_pk_bf16_f32 v85, v84, v83
    v_lshlrev_b32 v81, 16, v82
    v_lshlrev_b32 v84, 16, v85
    v_and_b32 v80, 0xffff0000, v82
    v_and_b32 v83, 0xffff0000, v85
    v_mul_f32 v81, s53, v81
    v_mul_f32 v84, s53, v84
    v_mul_f32 v80, s53, v80
    v_mul_f32 v83, s53, v83
    v_exp_f32 v81, v81
    v_exp_f32 v84, v84
    v_exp_f32 v80, v80
    v_exp_f32 v83, v83
    v_cvt_pk_bf16_f32 v82, v81, v80
    v_cvt_pk_bf16_f32 v85, v84, v83
    v_lshlrev_b32 v81, 16, v82
    v_lshlrev_b32 v84, 16, v85
    v_and_b32 v80, 0xffff0000, v82
    v_and_b32 v83, 0xffff0000, v85
    v_fma_f32 v81, v81, s55, v93
    v_fma_f32 v84, v84, s55, v93
    v_fma_f32 v80, v80, s55, v93
    v_fma_f32 v83, v83, s55, v93
    v_cvt_pk_bf16_f32 v244, v81, v80
    v_cvt_pk_bf16_f32 v245, v84, v83
    s_add_u32 s81, s81, 49152
    buffer_load_dwordx4 v[208:211], v19, s[44:47], s81 offen offset:0
    buffer_load_dwordx4 v[212:215], v19, s[44:47], s81 offen offset:1024
    v_cvt_pk_bf16_f32 v80, v252, v253
    v_cvt_pk_bf16_f32 v83, v254, v255
    v_lshlrev_b32 v81, 16, v80
    v_lshlrev_b32 v84, 16, v83
    v_and_b32 v80, 0xffff0000, v80
    v_and_b32 v83, 0xffff0000, v83
    v_sub_f32 v81, v81, v94
    v_sub_f32 v84, v84, v94
    v_sub_f32 v80, v80, v94
    v_sub_f32 v83, v83, v94
    v_cvt_pk_bf16_f32 v82, v81, v80
    v_cvt_pk_bf16_f32 v85, v84, v83
    v_lshlrev_b32 v81, 16, v82
    v_lshlrev_b32 v84, 16, v85
    v_and_b32 v80, 0xffff0000, v82
    v_and_b32 v83, 0xffff0000, v85
    v_mul_f32 v81, s53, v81
    v_mul_f32 v84, s53, v84
    v_mul_f32 v80, s53, v80
    v_mul_f32 v83, s53, v83
    v_exp_f32 v81, v81
    v_exp_f32 v84, v84
    v_exp_f32 v80, v80
    v_exp_f32 v83, v83
    v_cvt_pk_bf16_f32 v82, v81, v80
    v_cvt_pk_bf16_f32 v85, v84, v83
    v_lshlrev_b32 v81, 16, v82
    v_lshlrev_b32 v84, 16, v85
    v_and_b32 v80, 0xffff0000, v82
    v_and_b32 v83, 0xffff0000, v85
    v_fma_f32 v81, v81, s55, v93
    v_fma_f32 v84, v84, s55, v93
    v_fma_f32 v80, v80, s55, v93
    v_fma_f32 v83, v83, s55, v93
    v_cvt_pk_bf16_f32 v246, v81, v80
    v_cvt_pk_bf16_f32 v247, v84, v83
    s_add_u32 s81, s81, 49152
    buffer_load_dwordx4 v[216:219], v19, s[44:47], s81 offen offset:0
    buffer_load_dwordx4 v[220:223], v19, s[44:47], s81 offen offset:1024
    v_lshlrev_b32 v22, 2, v0
    s_lshl_b32 s61, s49, 11
    s_add_u32 s61, s61, 12582912
    buffer_load_dword v32, v22, s[44:47], s61 offen offset:0
    s_add_u32 s61, s61, 256
    buffer_load_dword v33, v22, s[44:47], s61 offen offset:0
    s_add_u32 s61, s61, 256
    buffer_load_dword v34, v22, s[44:47], s61 offen offset:0
    s_add_u32 s61, s61, 256
    buffer_load_dword v35, v22, s[44:47], s61 offen offset:0
    s_add_u32 s61, s61, 256
    buffer_load_dword v36, v22, s[44:47], s61 offen offset:0
    s_add_u32 s61, s61, 256
    buffer_load_dword v37, v22, s[44:47], s61 offen offset:0
    s_add_u32 s61, s61, 256
    buffer_load_dword v38, v22, s[44:47], s61 offen offset:0
    s_add_u32 s61, s61, 256
    buffer_load_dword v39, v22, s[44:47], s61 offen offset:0
    s_waitcnt vmcnt(24)
    v_add_f32 v80, v96, v104
    v_add_f32 v80, v80, v112
    v_add_f32 v80, v80, v120
    v_add_f32 v80, v80, v128
    v_add_f32 v80, v80, v136
    v_add_f32 v80, v80, v144
    v_add_f32 v80, v80, v152
    v_add_f32 v81, v97, v105
    v_add_f32 v81, v81, v113
    v_add_f32 v81, v81, v121
    v_add_f32 v81, v81, v129
    v_add_f32 v81, v81, v137
    v_add_f32 v81, v81, v145
    v_add_f32 v81, v81, v153
    v_add_f32 v82, v98, v106
    v_add_f32 v82, v82, v114
    v_add_f32 v82, v82, v122
    v_add_f32 v82, v82, v130
    v_add_f32 v82, v82, v138
    v_add_f32 v82, v82, v146
    v_add_f32 v82, v82, v154
    v_add_f32 v83, v99, v107
    v_add_f32 v83, v83, v115
    v_add_f32 v83, v83, v123
    v_add_f32 v83, v83, v131
    v_add_f32 v83, v83, v139
    v_add_f32 v83, v83, v147
    v_add_f32 v83, v83, v155
    v_cvt_pk_bf16_f32 v84, v80, v81
    v_cvt_pk_bf16_f32 v85, v82, v83
    v_add_f32 v80, v100, v108
    v_add_f32 v80, v80, v116
    v_add_f32 v80, v80, v124
    v_add_f32 v80, v80, v132
    v_add_f32 v80, v80, v140
    v_add_f32 v80, v80, v148
    v_add_f32 v80, v80, v156
    v_add_f32 v81, v101, v109
    v_add_f32 v81, v81, v117
    v_add_f32 v81, v81, v125
    v_add_f32 v81, v81, v133
    v_add_f32 v81, v81, v141
    v_add_f32 v81, v81, v149
    v_add_f32 v81, v81, v157
    v_add_f32 v82, v102, v110
    v_add_f32 v82, v82, v118
    v_add_f32 v82, v82, v126
    v_add_f32 v82, v82, v134
    v_add_f32 v82, v82, v142
    v_add_f32 v82, v82, v150
    v_add_f32 v82, v82, v158
    v_add_f32 v83, v103, v111
    v_add_f32 v83, v83, v119
    v_add_f32 v83, v83, v127
    v_add_f32 v83, v83, v135
    v_add_f32 v83, v83, v143
    v_add_f32 v83, v83, v151
    v_add_f32 v83, v83, v159
    v_cvt_pk_bf16_f32 v86, v80, v81
    v_cvt_pk_bf16_f32 v87, v82, v83
    ds_write_b128 v31, v[84:87] offset:0
    s_add_u32 s81, s80, 4096
    buffer_load_dwordx4 v[96:99], v19, s[44:47], s81 offen offset:0
    buffer_load_dwordx4 v[100:103], v19, s[44:47], s81 offen offset:1024
    s_add_u32 s81, s81, 49152
    buffer_load_dwordx4 v[104:107], v19, s[44:47], s81 offen offset:0
    buffer_load_dwordx4 v[108:111], v19, s[44:47], s81 offen offset:1024
    s_add_u32 s81, s81, 49152
    buffer_load_dwordx4 v[112:115], v19, s[44:47], s81 offen offset:0
    buffer_load_dwordx4 v[116:119], v19, s[44:47], s81 offen offset:1024
    s_add_u32 s81, s81, 49152
    buffer_load_dwordx4 v[120:123], v19, s[44:47], s81 offen offset:0
    buffer_load_dwordx4 v[124:127], v19, s[44:47], s81 offen offset:1024
    s_add_u32 s81, s81, 49152
    buffer_load_dwordx4 v[128:131], v19, s[44:47], s81 offen offset:0
    buffer_load_dwordx4 v[132:135], v19, s[44:47], s81 offen offset:1024
    s_add_u32 s81, s81, 49152
    buffer_load_dwordx4 v[136:139], v19, s[44:47], s81 offen offset:0
    buffer_load_dwordx4 v[140:143], v19, s[44:47], s81 offen offset:1024
    s_add_u32 s81, s81, 49152
    buffer_load_dwordx4 v[144:147], v19, s[44:47], s81 offen offset:0
    buffer_load_dwordx4 v[148:151], v19, s[44:47], s81 offen offset:1024
    s_add_u32 s81, s81, 49152
    buffer_load_dwordx4 v[152:155], v19, s[44:47], s81 offen offset:0
    buffer_load_dwordx4 v[156:159], v19, s[44:47], s81 offen offset:1024
    s_waitcnt vmcnt(24)
    v_add_f32 v80, v160, v168
    v_add_f32 v80, v80, v176
    v_add_f32 v80, v80, v184
    v_add_f32 v80, v80, v192
    v_add_f32 v80, v80, v200
    v_add_f32 v80, v80, v208
    v_add_f32 v80, v80, v216
    v_add_f32 v81, v161, v169
    v_add_f32 v81, v81, v177
    v_add_f32 v81, v81, v185
    v_add_f32 v81, v81, v193
    v_add_f32 v81, v81, v201
    v_add_f32 v81, v81, v209
    v_add_f32 v81, v81, v217
    v_add_f32 v82, v162, v170
    v_add_f32 v82, v82, v178
    v_add_f32 v82, v82, v186
    v_add_f32 v82, v82, v194
    v_add_f32 v82, v82, v202
    v_add_f32 v82, v82, v210
    v_add_f32 v82, v82, v218
    v_add_f32 v83, v163, v171
    v_add_f32 v83, v83, v179
    v_add_f32 v83, v83, v187
    v_add_f32 v83, v83, v195
    v_add_f32 v83, v83, v203
    v_add_f32 v83, v83, v211
    v_add_f32 v83, v83, v219
    v_cvt_pk_bf16_f32 v84, v80, v81
    v_cvt_pk_bf16_f32 v85, v82, v83
    v_add_f32 v80, v164, v172
    v_add_f32 v80, v80, v180
    v_add_f32 v80, v80, v188
    v_add_f32 v80, v80, v196
    v_add_f32 v80, v80, v204
    v_add_f32 v80, v80, v212
    v_add_f32 v80, v80, v220
    v_add_f32 v81, v165, v173
    v_add_f32 v81, v81, v181
    v_add_f32 v81, v81, v189
    v_add_f32 v81, v81, v197
    v_add_f32 v81, v81, v205
    v_add_f32 v81, v81, v213
    v_add_f32 v81, v81, v221
    v_add_f32 v82, v166, v174
    v_add_f32 v82, v82, v182
    v_add_f32 v82, v82, v190
    v_add_f32 v82, v82, v198
    v_add_f32 v82, v82, v206
    v_add_f32 v82, v82, v214
    v_add_f32 v82, v82, v222
    v_add_f32 v83, v167, v175
    v_add_f32 v83, v83, v183
    v_add_f32 v83, v83, v191
    v_add_f32 v83, v83, v199
    v_add_f32 v83, v83, v207
    v_add_f32 v83, v83, v215
    v_add_f32 v83, v83, v223
    v_cvt_pk_bf16_f32 v86, v80, v81
    v_cvt_pk_bf16_f32 v87, v82, v83
    ds_write_b128 v31, v[84:87] offset:1024
    s_waitcnt vmcnt(16)
    v_add_f32 v32, v32, v33
    v_add_f32 v32, v32, v34
    v_add_f32 v32, v32, v35
    v_add_f32 v32, v32, v36
    v_add_f32 v32, v32, v37
    v_add_f32 v32, v32, v38
    v_add_f32 v32, v32, v39
    v_cvt_pk_bf16_f32 v32, v32, v32
    v_lshlrev_b32 v23, 1, v0
    v_add_u32 v23, 49152, v23
    ds_write_b16 v23, v32 offset:0
    s_waitcnt vmcnt(0)
    v_add_f32 v80, v96, v104
    v_add_f32 v80, v80, v112
    v_add_f32 v80, v80, v120
    v_add_f32 v80, v80, v128
    v_add_f32 v80, v80, v136
    v_add_f32 v80, v80, v144
    v_add_f32 v80, v80, v152
    v_add_f32 v81, v97, v105
    v_add_f32 v81, v81, v113
    v_add_f32 v81, v81, v121
    v_add_f32 v81, v81, v129
    v_add_f32 v81, v81, v137
    v_add_f32 v81, v81, v145
    v_add_f32 v81, v81, v153
    v_add_f32 v82, v98, v106
    v_add_f32 v82, v82, v114
    v_add_f32 v82, v82, v122
    v_add_f32 v82, v82, v130
    v_add_f32 v82, v82, v138
    v_add_f32 v82, v82, v146
    v_add_f32 v82, v82, v154
    v_add_f32 v83, v99, v107
    v_add_f32 v83, v83, v115
    v_add_f32 v83, v83, v123
    v_add_f32 v83, v83, v131
    v_add_f32 v83, v83, v139
    v_add_f32 v83, v83, v147
    v_add_f32 v83, v83, v155
    v_cvt_pk_bf16_f32 v84, v80, v81
    v_cvt_pk_bf16_f32 v85, v82, v83
    v_add_f32 v80, v100, v108
    v_add_f32 v80, v80, v116
    v_add_f32 v80, v80, v124
    v_add_f32 v80, v80, v132
    v_add_f32 v80, v80, v140
    v_add_f32 v80, v80, v148
    v_add_f32 v80, v80, v156
    v_add_f32 v81, v101, v109
    v_add_f32 v81, v81, v117
    v_add_f32 v81, v81, v125
    v_add_f32 v81, v81, v133
    v_add_f32 v81, v81, v141
    v_add_f32 v81, v81, v149
    v_add_f32 v81, v81, v157
    v_add_f32 v82, v102, v110
    v_add_f32 v82, v82, v118
    v_add_f32 v82, v82, v126
    v_add_f32 v82, v82, v134
    v_add_f32 v82, v82, v142
    v_add_f32 v82, v82, v150
    v_add_f32 v82, v82, v158
    v_add_f32 v83, v103, v111
    v_add_f32 v83, v83, v119
    v_add_f32 v83, v83, v127
    v_add_f32 v83, v83, v135
    v_add_f32 v83, v83, v143
    v_add_f32 v83, v83, v151
    v_add_f32 v83, v83, v159
    v_cvt_pk_bf16_f32 v86, v80, v81
    v_cvt_pk_bf16_f32 v87, v82, v83
    ds_write_b128 v31, v[84:87] offset:2048
    s_waitcnt lgkmcnt(0)
    s_barrier
    ds_read_b64 v[128:129], v20 offset:0
    ds_read_b64 v[130:131], v20 offset:16
    ds_read_b64 v[132:133], v20 offset:32
    ds_read_b64 v[134:135], v20 offset:48
    ds_read_b64 v[136:137], v20 offset:64
    ds_read_b64 v[138:139], v20 offset:80
    ds_read_b64 v[140:141], v20 offset:96
    ds_read_b64 v[142:143], v20 offset:112
    v_mov_b32 v80, 0
    s_waitcnt lgkmcnt(0)
    v_dot2c_f32_bf16 v80, v224, v128
    v_dot2c_f32_bf16 v80, v225, v129
    v_dot2c_f32_bf16 v80, v226, v130
    v_dot2c_f32_bf16 v80, v227, v131
    v_dot2c_f32_bf16 v80, v228, v132
    v_dot2c_f32_bf16 v80, v229, v133
    v_dot2c_f32_bf16 v80, v230, v134
    v_dot2c_f32_bf16 v80, v231, v135
    v_dot2c_f32_bf16 v80, v240, v136
    v_dot2c_f32_bf16 v80, v241, v137
    v_dot2c_f32_bf16 v80, v242, v138
    v_dot2c_f32_bf16 v80, v243, v139
    v_dot2c_f32_bf16 v80, v244, v140
    v_dot2c_f32_bf16 v80, v245, v141
    v_dot2c_f32_bf16 v80, v246, v142
    v_dot2c_f32_bf16 v80, v247, v143
    s_nop 2
    v_mov_b32 v81, v80
    v_mov_b32 v82, v80
    s_nop 1
    v_permlane32_swap_b32 v81, v82
    v_add_f32 v81, v81, v82
    v_cvt_pk_bf16_f32 v82, v81, v81
    v_lshlrev_b32 v82, 16, v82
    v_add_f32 v82, s54, v82
    v_cvt_pk_bf16_f32 v81, v82, v82
    v_lshlrev_b32 v83, 16, v81
    v_rcp_f32 v84, v83
    s_nop 0
    v_fma_f32 v81, -v83, v84, 1.0
    v_fma_f32 v84, v81, v84, v84
    s_mul_i32 s60, s48, 12288
    s_add_u32 s60, s60, s56
    s_add_u32 s64, s60, 3072
    s_add_u32 s65, s60, 6144
    s_add_u32 s66, s60, 9216
    ds_read_b128 v[176:179], v19 offset:24576
    ds_read_b128 v[180:183], v19 offset:25600
    ds_read_b128 v[184:187], v19 offset:26624
    ds_read_b128 v[188:191], v19 offset:27648
    ds_read_b128 v[192:195], v19 offset:28672
    ds_read_b128 v[196:199], v19 offset:29696
    ds_read_b128 v[200:203], v19 offset:30720
    ds_read_b128 v[204:207], v19 offset:31744
    s_waitcnt lgkmcnt(4)
    v_mfma_f32_32x32x16_bf16 v[112:127], v[176:179], v[224:227], 0
    v_mfma_f32_32x32x16_bf16 v[112:127], v[180:183], v[228:231], v[112:127]
    v_mfma_f32_32x32x16_bf16 v[112:127], v[184:187], v[240:243], v[112:127]
    v_mfma_f32_32x32x16_bf16 v[112:127], v[188:191], v[244:247], v[112:127]
    s_waitcnt lgkmcnt(0)
    v_mfma_f32_32x32x16_bf16 v[144:159], v[192:195], v[224:227], 0
    v_mfma_f32_32x32x16_bf16 v[144:159], v[196:199], v[228:231], v[144:159]
    v_mfma_f32_32x32x16_bf16 v[144:159], v[200:203], v[240:243], v[144:159]
    v_mfma_f32_32x32x16_bf16 v[144:159], v[204:207], v[244:247], v[144:159]
    ds_read_b128 v[176:179], v19 offset:32768
    ds_read_b128 v[180:183], v19 offset:33792
    ds_read_b128 v[184:187], v19 offset:34816
    ds_read_b128 v[188:191], v19 offset:35840
    s_nop 2
    v_cvt_pk_bf16_f32 v85, v112, v113
    v_cvt_pk_bf16_f32 v92, v114, v115
    v_lshlrev_b32 v86, 16, v85
    v_lshlrev_b32 v93, 16, v92
    v_and_b32 v85, 0xffff0000, v85
    v_and_b32 v92, 0xffff0000, v92
    v_mul_f32 v87, v86, v84
    v_mul_f32 v94, v93, v84
    v_mul_f32 v88, v85, v84
    v_mul_f32 v95, v92, v84
    v_fma_f32 v86, -v87, v83, v86
    v_fma_f32 v93, -v94, v83, v93
    v_fma_f32 v85, -v88, v83, v85
    v_fma_f32 v92, -v95, v83, v92
    v_fma_f32 v87, v86, v84, v87
    v_fma_f32 v94, v93, v84, v94
    v_fma_f32 v88, v85, v84, v88
    v_fma_f32 v95, v92, v84, v95
    v_cvt_pk_bf16_f32 v90, v87, v88
    v_cvt_pk_bf16_f32 v91, v94, v95
    ds_write_b64 v14, v[90:91] offset:0
    v_cvt_pk_bf16_f32 v85, v116, v117
    v_cvt_pk_bf16_f32 v92, v118, v119
    v_lshlrev_b32 v86, 16, v85
    v_lshlrev_b32 v93, 16, v92
    v_and_b32 v85, 0xffff0000, v85
    v_and_b32 v92, 0xffff0000, v92
    v_mul_f32 v87, v86, v84
    v_mul_f32 v94, v93, v84
    v_mul_f32 v88, v85, v84
    v_mul_f32 v95, v92, v84
    v_fma_f32 v86, -v87, v83, v86
    v_fma_f32 v93, -v94, v83, v93
    v_fma_f32 v85, -v88, v83, v85
    v_fma_f32 v92, -v95, v83, v92
    v_fma_f32 v87, v86, v84, v87
    v_fma_f32 v94, v93, v84, v94
    v_fma_f32 v88, v85, v84, v88
    v_fma_f32 v95, v92, v84, v95
    v_cvt_pk_bf16_f32 v90, v87, v88
    v_cvt_pk_bf16_f32 v91, v94, v95
    ds_write_b64 v14, v[90:91] offset:16
    v_cvt_pk_bf16_f32 v85, v120, v121
    v_cvt_pk_bf16_f32 v92, v122, v123
    v_lshlrev_b32 v86, 16, v85
    v_lshlrev_b32 v93, 16, v92
    v_and_b32 v85, 0xffff0000, v85
    v_and_b32 v92, 0xffff0000, v92
    v_mul_f32 v87, v86, v84
    v_mul_f32 v94, v93, v84
    v_mul_f32 v88, v85, v84
    v_mul_f32 v95, v92, v84
    v_fma_f32 v86, -v87, v83, v86
    v_fma_f32 v93, -v94, v83, v93
    v_fma_f32 v85, -v88, v83, v85
    v_fma_f32 v92, -v95, v83, v92
    v_fma_f32 v87, v86, v84, v87
    v_fma_f32 v94, v93, v84, v94
    v_fma_f32 v88, v85, v84, v88
    v_fma_f32 v95, v92, v84, v95
    v_cvt_pk_bf16_f32 v90, v87, v88
    v_cvt_pk_bf16_f32 v91, v94, v95
    ds_write_b64 v14, v[90:91] offset:32
    v_cvt_pk_bf16_f32 v85, v124, v125
    v_cvt_pk_bf16_f32 v92, v126, v127
    v_lshlrev_b32 v86, 16, v85
    v_lshlrev_b32 v93, 16, v92
    v_and_b32 v85, 0xffff0000, v85
    v_and_b32 v92, 0xffff0000, v92
    v_mul_f32 v87, v86, v84
    v_mul_f32 v94, v93, v84
    v_mul_f32 v88, v85, v84
    v_mul_f32 v95, v92, v84
    v_fma_f32 v86, -v87, v83, v86
    v_fma_f32 v93, -v94, v83, v93
    v_fma_f32 v85, -v88, v83, v85
    v_fma_f32 v92, -v95, v83, v92
    v_fma_f32 v87, v86, v84, v87
    v_fma_f32 v94, v93, v84, v94
    v_fma_f32 v88, v85, v84, v88
    v_fma_f32 v95, v92, v84, v95
    v_cvt_pk_bf16_f32 v90, v87, v88
    v_cvt_pk_bf16_f32 v91, v94, v95
    ds_write_b64 v14, v[90:91] offset:48
    s_waitcnt lgkmcnt(0)
    v_mfma_f32_32x32x16_bf16 v[112:127], v[176:179], v[224:227], 0
    v_mfma_f32_32x32x16_bf16 v[112:127], v[180:183], v[228:231], v[112:127]
    v_mfma_f32_32x32x16_bf16 v[112:127], v[184:187], v[240:243], v[112:127]
    v_mfma_f32_32x32x16_bf16 v[112:127], v[188:191], v[244:247], v[112:127]
    ds_read_b128 v[192:195], v19 offset:36864
    ds_read_b128 v[196:199], v19 offset:37888
    ds_read_b128 v[200:203], v19 offset:38912
    ds_read_b128 v[204:207], v19 offset:39936
    v_cvt_pk_bf16_f32 v85, v144, v145
    v_cvt_pk_bf16_f32 v92, v146, v147
    v_lshlrev_b32 v86, 16, v85
    v_lshlrev_b32 v93, 16, v92
    v_and_b32 v85, 0xffff0000, v85
    v_and_b32 v92, 0xffff0000, v92
    v_mul_f32 v87, v86, v84
    v_mul_f32 v94, v93, v84
    v_mul_f32 v88, v85, v84
    v_mul_f32 v95, v92, v84
    v_fma_f32 v86, -v87, v83, v86
    v_fma_f32 v93, -v94, v83, v93
    v_fma_f32 v85, -v88, v83, v85
    v_fma_f32 v92, -v95, v83, v92
    v_fma_f32 v87, v86, v84, v87
    v_fma_f32 v94, v93, v84, v94
    v_fma_f32 v88, v85, v84, v88
    v_fma_f32 v95, v92, v84, v95
    v_cvt_pk_bf16_f32 v90, v87, v88
    v_cvt_pk_bf16_f32 v91, v94, v95
    ds_write_b64 v14, v[90:91] offset:64
    v_cvt_pk_bf16_f32 v85, v148, v149
    v_cvt_pk_bf16_f32 v92, v150, v151
    v_lshlrev_b32 v86, 16, v85
    v_lshlrev_b32 v93, 16, v92
    v_and_b32 v85, 0xffff0000, v85
    v_and_b32 v92, 0xffff0000, v92
    v_mul_f32 v87, v86, v84
    v_mul_f32 v94, v93, v84
    v_mul_f32 v88, v85, v84
    v_mul_f32 v95, v92, v84
    v_fma_f32 v86, -v87, v83, v86
    v_fma_f32 v93, -v94, v83, v93
    v_fma_f32 v85, -v88, v83, v85
    v_fma_f32 v92, -v95, v83, v92
    v_fma_f32 v87, v86, v84, v87
    v_fma_f32 v94, v93, v84, v94
    v_fma_f32 v88, v85, v84, v88
    v_fma_f32 v95, v92, v84, v95
    v_cvt_pk_bf16_f32 v90, v87, v88
    v_cvt_pk_bf16_f32 v91, v94, v95
    ds_write_b64 v14, v[90:91] offset:80
    v_cvt_pk_bf16_f32 v85, v152, v153
    v_cvt_pk_bf16_f32 v92, v154, v155
    v_lshlrev_b32 v86, 16, v85
    v_lshlrev_b32 v93, 16, v92
    v_and_b32 v85, 0xffff0000, v85
    v_and_b32 v92, 0xffff0000, v92
    v_mul_f32 v87, v86, v84
    v_mul_f32 v94, v93, v84
    v_mul_f32 v88, v85, v84
    v_mul_f32 v95, v92, v84
    v_fma_f32 v86, -v87, v83, v86
    v_fma_f32 v93, -v94, v83, v93
    v_fma_f32 v85, -v88, v83, v85
    v_fma_f32 v92, -v95, v83, v92
    v_fma_f32 v87, v86, v84, v87
    v_fma_f32 v94, v93, v84, v94
    v_fma_f32 v88, v85, v84, v88
    v_fma_f32 v95, v92, v84, v95
    v_cvt_pk_bf16_f32 v90, v87, v88
    v_cvt_pk_bf16_f32 v91, v94, v95
    ds_write_b64 v14, v[90:91] offset:96
    v_cvt_pk_bf16_f32 v85, v156, v157
    v_cvt_pk_bf16_f32 v92, v158, v159
    v_lshlrev_b32 v86, 16, v85
    v_lshlrev_b32 v93, 16, v92
    v_and_b32 v85, 0xffff0000, v85
    v_and_b32 v92, 0xffff0000, v92
    v_mul_f32 v87, v86, v84
    v_mul_f32 v94, v93, v84
    v_mul_f32 v88, v85, v84
    v_mul_f32 v95, v92, v84
    v_fma_f32 v86, -v87, v83, v86
    v_fma_f32 v93, -v94, v83, v93
    v_fma_f32 v85, -v88, v83, v85
    v_fma_f32 v92, -v95, v83, v92
    v_fma_f32 v87, v86, v84, v87
    v_fma_f32 v94, v93, v84, v94
    v_fma_f32 v88, v85, v84, v88
    v_fma_f32 v95, v92, v84, v95
    v_cvt_pk_bf16_f32 v90, v87, v88
    v_cvt_pk_bf16_f32 v91, v94, v95
    ds_write_b64 v14, v[90:91] offset:112
    s_waitcnt lgkmcnt(0)
    ds_read_b128 v[96:99], v15 offset:0
    ds_read_b128 v[100:103], v15 offset:3200
    ds_read_b128 v[104:107], v15 offset:6400
    ds_read_b128 v[108:111], v15 offset:9600
    s_waitcnt lgkmcnt(3)
    buffer_store_dwordx4 v[96:99], v16, s[36:39], s60 offen offset:0
    s_waitcnt lgkmcnt(2)
    buffer_store_dwordx4 v[100:103], v16, s[36:39], s64 offen offset:0
    s_waitcnt lgkmcnt(1)
    buffer_store_dwordx4 v[104:107], v16, s[36:39], s65 offen offset:0
    s_waitcnt lgkmcnt(0)
    buffer_store_dwordx4 v[108:111], v16, s[36:39], s66 offen offset:0
    s_waitcnt lgkmcnt(0)
    v_mfma_f32_32x32x16_bf16 v[144:159], v[192:195], v[224:227], 0
    v_mfma_f32_32x32x16_bf16 v[144:159], v[196:199], v[228:231], v[144:159]
    v_mfma_f32_32x32x16_bf16 v[144:159], v[200:203], v[240:243], v[144:159]
    v_mfma_f32_32x32x16_bf16 v[144:159], v[204:207], v[244:247], v[144:159]
    ds_read_b128 v[176:179], v19 offset:40960
    ds_read_b128 v[180:183], v19 offset:41984
    ds_read_b128 v[184:187], v19 offset:43008
    ds_read_b128 v[188:191], v19 offset:44032
    v_cvt_pk_bf16_f32 v85, v112, v113
    v_cvt_pk_bf16_f32 v92, v114, v115
    v_lshlrev_b32 v86, 16, v85
    v_lshlrev_b32 v93, 16, v92
    v_and_b32 v85, 0xffff0000, v85
    v_and_b32 v92, 0xffff0000, v92
    v_mul_f32 v87, v86, v84
    v_mul_f32 v94, v93, v84
    v_mul_f32 v88, v85, v84
    v_mul_f32 v95, v92, v84
    v_fma_f32 v86, -v87, v83, v86
    v_fma_f32 v93, -v94, v83, v93
    v_fma_f32 v85, -v88, v83, v85
    v_fma_f32 v92, -v95, v83, v92
    v_fma_f32 v87, v86, v84, v87
    v_fma_f32 v94, v93, v84, v94
    v_fma_f32 v88, v85, v84, v88
    v_fma_f32 v95, v92, v84, v95
    v_cvt_pk_bf16_f32 v90, v87, v88
    v_cvt_pk_bf16_f32 v91, v94, v95
    ds_write_b64 v14, v[90:91] offset:128
    v_cvt_pk_bf16_f32 v85, v116, v117
    v_cvt_pk_bf16_f32 v92, v118, v119
    v_lshlrev_b32 v86, 16, v85
    v_lshlrev_b32 v93, 16, v92
    v_and_b32 v85, 0xffff0000, v85
    v_and_b32 v92, 0xffff0000, v92
    v_mul_f32 v87, v86, v84
    v_mul_f32 v94, v93, v84
    v_mul_f32 v88, v85, v84
    v_mul_f32 v95, v92, v84
    v_fma_f32 v86, -v87, v83, v86
    v_fma_f32 v93, -v94, v83, v93
    v_fma_f32 v85, -v88, v83, v85
    v_fma_f32 v92, -v95, v83, v92
    v_fma_f32 v87, v86, v84, v87
    v_fma_f32 v94, v93, v84, v94
    v_fma_f32 v88, v85, v84, v88
    v_fma_f32 v95, v92, v84, v95
    v_cvt_pk_bf16_f32 v90, v87, v88
    v_cvt_pk_bf16_f32 v91, v94, v95
    ds_write_b64 v14, v[90:91] offset:144
    v_cvt_pk_bf16_f32 v85, v120, v121
    v_cvt_pk_bf16_f32 v92, v122, v123
    v_lshlrev_b32 v86, 16, v85
    v_lshlrev_b32 v93, 16, v92
    v_and_b32 v85, 0xffff0000, v85
    v_and_b32 v92, 0xffff0000, v92
    v_mul_f32 v87, v86, v84
    v_mul_f32 v94, v93, v84
    v_mul_f32 v88, v85, v84
    v_mul_f32 v95, v92, v84
    v_fma_f32 v86, -v87, v83, v86
    v_fma_f32 v93, -v94, v83, v93
    v_fma_f32 v85, -v88, v83, v85
    v_fma_f32 v92, -v95, v83, v92
    v_fma_f32 v87, v86, v84, v87
    v_fma_f32 v94, v93, v84, v94
    v_fma_f32 v88, v85, v84, v88
    v_fma_f32 v95, v92, v84, v95
    v_cvt_pk_bf16_f32 v90, v87, v88
    v_cvt_pk_bf16_f32 v91, v94, v95
    ds_write_b64 v14, v[90:91] offset:160
    v_cvt_pk_bf16_f32 v85, v124, v125
    v_cvt_pk_bf16_f32 v92, v126, v127
    v_lshlrev_b32 v86, 16, v85
    v_lshlrev_b32 v93, 16, v92
    v_and_b32 v85, 0xffff0000, v85
    v_and_b32 v92, 0xffff0000, v92
    v_mul_f32 v87, v86, v84
    v_mul_f32 v94, v93, v84
    v_mul_f32 v88, v85, v84
    v_mul_f32 v95, v92, v84
    v_fma_f32 v86, -v87, v83, v86
    v_fma_f32 v93, -v94, v83, v93
    v_fma_f32 v85, -v88, v83, v85
    v_fma_f32 v92, -v95, v83, v92
    v_fma_f32 v87, v86, v84, v87
    v_fma_f32 v94, v93, v84, v94
    v_fma_f32 v88, v85, v84, v88
    v_fma_f32 v95, v92, v84, v95
    v_cvt_pk_bf16_f32 v90, v87, v88
    v_cvt_pk_bf16_f32 v91, v94, v95
    ds_write_b64 v14, v[90:91] offset:176
    s_waitcnt lgkmcnt(0)
    v_mfma_f32_32x32x16_bf16 v[112:127], v[176:179], v[224:227], 0
    v_mfma_f32_32x32x16_bf16 v[112:127], v[180:183], v[228:231], v[112:127]
    v_mfma_f32_32x32x16_bf16 v[112:127], v[184:187], v[240:243], v[112:127]
    v_mfma_f32_32x32x16_bf16 v[112:127], v[188:191], v[244:247], v[112:127]
    ds_read_b128 v[192:195], v19 offset:45056
    ds_read_b128 v[196:199], v19 offset:46080
    ds_read_b128 v[200:203], v19 offset:47104
    ds_read_b128 v[204:207], v19 offset:48128
    v_cvt_pk_bf16_f32 v85, v144, v145
    v_cvt_pk_bf16_f32 v92, v146, v147
    v_lshlrev_b32 v86, 16, v85
    v_lshlrev_b32 v93, 16, v92
    v_and_b32 v85, 0xffff0000, v85
    v_and_b32 v92, 0xffff0000, v92
    v_mul_f32 v87, v86, v84
    v_mul_f32 v94, v93, v84
    v_mul_f32 v88, v85, v84
    v_mul_f32 v95, v92, v84
    v_fma_f32 v86, -v87, v83, v86
    v_fma_f32 v93, -v94, v83, v93
    v_fma_f32 v85, -v88, v83, v85
    v_fma_f32 v92, -v95, v83, v92
    v_fma_f32 v87, v86, v84, v87
    v_fma_f32 v94, v93, v84, v94
    v_fma_f32 v88, v85, v84, v88
    v_fma_f32 v95, v92, v84, v95
    v_cvt_pk_bf16_f32 v90, v87, v88
    v_cvt_pk_bf16_f32 v91, v94, v95
    ds_write_b64 v14, v[90:91] offset:192
    v_cvt_pk_bf16_f32 v85, v148, v149
    v_cvt_pk_bf16_f32 v92, v150, v151
    v_lshlrev_b32 v86, 16, v85
    v_lshlrev_b32 v93, 16, v92
    v_and_b32 v85, 0xffff0000, v85
    v_and_b32 v92, 0xffff0000, v92
    v_mul_f32 v87, v86, v84
    v_mul_f32 v94, v93, v84
    v_mul_f32 v88, v85, v84
    v_mul_f32 v95, v92, v84
    v_fma_f32 v86, -v87, v83, v86
    v_fma_f32 v93, -v94, v83, v93
    v_fma_f32 v85, -v88, v83, v85
    v_fma_f32 v92, -v95, v83, v92
    v_fma_f32 v87, v86, v84, v87
    v_fma_f32 v94, v93, v84, v94
    v_fma_f32 v88, v85, v84, v88
    v_fma_f32 v95, v92, v84, v95
    v_cvt_pk_bf16_f32 v90, v87, v88
    v_cvt_pk_bf16_f32 v91, v94, v95
    ds_write_b64 v14, v[90:91] offset:208
    v_cvt_pk_bf16_f32 v85, v152, v153
    v_cvt_pk_bf16_f32 v92, v154, v155
    v_lshlrev_b32 v86, 16, v85
    v_lshlrev_b32 v93, 16, v92
    v_and_b32 v85, 0xffff0000, v85
    v_and_b32 v92, 0xffff0000, v92
    v_mul_f32 v87, v86, v84
    v_mul_f32 v94, v93, v84
    v_mul_f32 v88, v85, v84
    v_mul_f32 v95, v92, v84
    v_fma_f32 v86, -v87, v83, v86
    v_fma_f32 v93, -v94, v83, v93
    v_fma_f32 v85, -v88, v83, v85
    v_fma_f32 v92, -v95, v83, v92
    v_fma_f32 v87, v86, v84, v87
    v_fma_f32 v94, v93, v84, v94
    v_fma_f32 v88, v85, v84, v88
    v_fma_f32 v95, v92, v84, v95
    v_cvt_pk_bf16_f32 v90, v87, v88
    v_cvt_pk_bf16_f32 v91, v94, v95
    ds_write_b64 v14, v[90:91] offset:224
    v_cvt_pk_bf16_f32 v85, v156, v157
    v_cvt_pk_bf16_f32 v92, v158, v159
    v_lshlrev_b32 v86, 16, v85
    v_lshlrev_b32 v93, 16, v92
    v_and_b32 v85, 0xffff0000, v85
    v_and_b32 v92, 0xffff0000, v92
    v_mul_f32 v87, v86, v84
    v_mul_f32 v94, v93, v84
    v_mul_f32 v88, v85, v84
    v_mul_f32 v95, v92, v84
    v_fma_f32 v86, -v87, v83, v86
    v_fma_f32 v93, -v94, v83, v93
    v_fma_f32 v85, -v88, v83, v85
    v_fma_f32 v92, -v95, v83, v92
    v_fma_f32 v87, v86, v84, v87
    v_fma_f32 v94, v93, v84, v94
    v_fma_f32 v88, v85, v84, v88
    v_fma_f32 v95, v92, v84, v95
    v_cvt_pk_bf16_f32 v90, v87, v88
    v_cvt_pk_bf16_f32 v91, v94, v95
    ds_write_b64 v14, v[90:91] offset:240
    s_waitcnt lgkmcnt(0)
    ds_read_b128 v[96:99], v15 offset:128
    ds_read_b128 v[100:103], v15 offset:3328
    ds_read_b128 v[104:107], v15 offset:6528
    ds_read_b128 v[108:111], v15 offset:9728
    s_waitcnt lgkmcnt(3)
    buffer_store_dwordx4 v[96:99], v16, s[36:39], s60 offen offset:128
    s_waitcnt lgkmcnt(2)
    buffer_store_dwordx4 v[100:103], v16, s[36:39], s64 offen offset:128
    s_waitcnt lgkmcnt(1)
    buffer_store_dwordx4 v[104:107], v16, s[36:39], s65 offen offset:128
    s_waitcnt lgkmcnt(0)
    buffer_store_dwordx4 v[108:111], v16, s[36:39], s66 offen offset:128
    s_waitcnt lgkmcnt(0)
    v_mfma_f32_32x32x16_bf16 v[144:159], v[192:195], v[224:227], 0
    v_mfma_f32_32x32x16_bf16 v[144:159], v[196:199], v[228:231], v[144:159]
    v_mfma_f32_32x32x16_bf16 v[144:159], v[200:203], v[240:243], v[144:159]
    v_mfma_f32_32x32x16_bf16 v[144:159], v[204:207], v[244:247], v[144:159]
    v_cvt_pk_bf16_f32 v85, v112, v113
    v_cvt_pk_bf16_f32 v92, v114, v115
    v_lshlrev_b32 v86, 16, v85
    v_lshlrev_b32 v93, 16, v92
    v_and_b32 v85, 0xffff0000, v85
    v_and_b32 v92, 0xffff0000, v92
    v_mul_f32 v87, v86, v84
    v_mul_f32 v94, v93, v84
    v_mul_f32 v88, v85, v84
    v_mul_f32 v95, v92, v84
    v_fma_f32 v86, -v87, v83, v86
    v_fma_f32 v93, -v94, v83, v93
    v_fma_f32 v85, -v88, v83, v85
    v_fma_f32 v92, -v95, v83, v92
    v_fma_f32 v87, v86, v84, v87
    v_fma_f32 v94, v93, v84, v94
    v_fma_f32 v88, v85, v84, v88
    v_fma_f32 v95, v92, v84, v95
    v_cvt_pk_bf16_f32 v90, v87, v88
    v_cvt_pk_bf16_f32 v91, v94, v95
    ds_write_b64 v14, v[90:91] offset:256
    v_cvt_pk_bf16_f32 v85, v116, v117
    v_cvt_pk_bf16_f32 v92, v118, v119
    v_lshlrev_b32 v86, 16, v85
    v_lshlrev_b32 v93, 16, v92
    v_and_b32 v85, 0xffff0000, v85
    v_and_b32 v92, 0xffff0000, v92
    v_mul_f32 v87, v86, v84
    v_mul_f32 v94, v93, v84
    v_mul_f32 v88, v85, v84
    v_mul_f32 v95, v92, v84
    v_fma_f32 v86, -v87, v83, v86
    v_fma_f32 v93, -v94, v83, v93
    v_fma_f32 v85, -v88, v83, v85
    v_fma_f32 v92, -v95, v83, v92
    v_fma_f32 v87, v86, v84, v87
    v_fma_f32 v94, v93, v84, v94
    v_fma_f32 v88, v85, v84, v88
    v_fma_f32 v95, v92, v84, v95
    v_cvt_pk_bf16_f32 v90, v87, v88
    v_cvt_pk_bf16_f32 v91, v94, v95
    ds_write_b64 v14, v[90:91] offset:272
    v_cvt_pk_bf16_f32 v85, v120, v121
    v_cvt_pk_bf16_f32 v92, v122, v123
    v_lshlrev_b32 v86, 16, v85
    v_lshlrev_b32 v93, 16, v92
    v_and_b32 v85, 0xffff0000, v85
    v_and_b32 v92, 0xffff0000, v92
    v_mul_f32 v87, v86, v84
    v_mul_f32 v94, v93, v84
    v_mul_f32 v88, v85, v84
    v_mul_f32 v95, v92, v84
    v_fma_f32 v86, -v87, v83, v86
    v_fma_f32 v93, -v94, v83, v93
    v_fma_f32 v85, -v88, v83, v85
    v_fma_f32 v92, -v95, v83, v92
    v_fma_f32 v87, v86, v84, v87
    v_fma_f32 v94, v93, v84, v94
    v_fma_f32 v88, v85, v84, v88
    v_fma_f32 v95, v92, v84, v95
    v_cvt_pk_bf16_f32 v90, v87, v88
    v_cvt_pk_bf16_f32 v91, v94, v95
    ds_write_b64 v14, v[90:91] offset:288
    v_cvt_pk_bf16_f32 v85, v124, v125
    v_cvt_pk_bf16_f32 v92, v126, v127
    v_lshlrev_b32 v86, 16, v85
    v_lshlrev_b32 v93, 16, v92
    v_and_b32 v85, 0xffff0000, v85
    v_and_b32 v92, 0xffff0000, v92
    v_mul_f32 v87, v86, v84
    v_mul_f32 v94, v93, v84
    v_mul_f32 v88, v85, v84
    v_mul_f32 v95, v92, v84
    v_fma_f32 v86, -v87, v83, v86
    v_fma_f32 v93, -v94, v83, v93
    v_fma_f32 v85, -v88, v83, v85
    v_fma_f32 v92, -v95, v83, v92
    v_fma_f32 v87, v86, v84, v87
    v_fma_f32 v94, v93, v84, v94
    v_fma_f32 v88, v85, v84, v88
    v_fma_f32 v95, v92, v84, v95
    v_cvt_pk_bf16_f32 v90, v87, v88
    v_cvt_pk_bf16_f32 v91, v94, v95
    ds_write_b64 v14, v[90:91] offset:304
    v_cvt_pk_bf16_f32 v85, v144, v145
    v_cvt_pk_bf16_f32 v92, v146, v147
    v_lshlrev_b32 v86, 16, v85
    v_lshlrev_b32 v93, 16, v92
    v_and_b32 v85, 0xffff0000, v85
    v_and_b32 v92, 0xffff0000, v92
    v_mul_f32 v87, v86, v84
    v_mul_f32 v94, v93, v84
    v_mul_f32 v88, v85, v84
    v_mul_f32 v95, v92, v84
    v_fma_f32 v86, -v87, v83, v86
    v_fma_f32 v93, -v94, v83, v93
    v_fma_f32 v85, -v88, v83, v85
    v_fma_f32 v92, -v95, v83, v92
    v_fma_f32 v87, v86, v84, v87
    v_fma_f32 v94, v93, v84, v94
    v_fma_f32 v88, v85, v84, v88
    v_fma_f32 v95, v92, v84, v95
    v_cvt_pk_bf16_f32 v90, v87, v88
    v_cvt_pk_bf16_f32 v91, v94, v95
    ds_write_b64 v14, v[90:91] offset:320
    v_cvt_pk_bf16_f32 v85, v148, v149
    v_cvt_pk_bf16_f32 v92, v150, v151
    v_lshlrev_b32 v86, 16, v85
    v_lshlrev_b32 v93, 16, v92
    v_and_b32 v85, 0xffff0000, v85
    v_and_b32 v92, 0xffff0000, v92
    v_mul_f32 v87, v86, v84
    v_mul_f32 v94, v93, v84
    v_mul_f32 v88, v85, v84
    v_mul_f32 v95, v92, v84
    v_fma_f32 v86, -v87, v83, v86
    v_fma_f32 v93, -v94, v83, v93
    v_fma_f32 v85, -v88, v83, v85
    v_fma_f32 v92, -v95, v83, v92
    v_fma_f32 v87, v86, v84, v87
    v_fma_f32 v94, v93, v84, v94
    v_fma_f32 v88, v85, v84, v88
    v_fma_f32 v95, v92, v84, v95
    v_cvt_pk_bf16_f32 v90, v87, v88
    v_cvt_pk_bf16_f32 v91, v94, v95
    ds_write_b64 v14, v[90:91] offset:336
    v_cvt_pk_bf16_f32 v85, v152, v153
    v_cvt_pk_bf16_f32 v92, v154, v155
    v_lshlrev_b32 v86, 16, v85
    v_lshlrev_b32 v93, 16, v92
    v_and_b32 v85, 0xffff0000, v85
    v_and_b32 v92, 0xffff0000, v92
    v_mul_f32 v87, v86, v84
    v_mul_f32 v94, v93, v84
    v_mul_f32 v88, v85, v84
    v_mul_f32 v95, v92, v84
    v_fma_f32 v86, -v87, v83, v86
    v_fma_f32 v93, -v94, v83, v93
    v_fma_f32 v85, -v88, v83, v85
    v_fma_f32 v92, -v95, v83, v92
    v_fma_f32 v87, v86, v84, v87
    v_fma_f32 v94, v93, v84, v94
    v_fma_f32 v88, v85, v84, v88
    v_fma_f32 v95, v92, v84, v95
    v_cvt_pk_bf16_f32 v90, v87, v88
    v_cvt_pk_bf16_f32 v91, v94, v95
    ds_write_b64 v14, v[90:91] offset:352
    v_cvt_pk_bf16_f32 v85, v156, v157
    v_cvt_pk_bf16_f32 v92, v158, v159
    v_lshlrev_b32 v86, 16, v85
    v_lshlrev_b32 v93, 16, v92
    v_and_b32 v85, 0xffff0000, v85
    v_and_b32 v92, 0xffff0000, v92
    v_mul_f32 v87, v86, v84
    v_mul_f32 v94, v93, v84
    v_mul_f32 v88, v85, v84
    v_mul_f32 v95, v92, v84
    v_fma_f32 v86, -v87, v83, v86
    v_fma_f32 v93, -v94, v83, v93
    v_fma_f32 v85, -v88, v83, v85
    v_fma_f32 v92, -v95, v83, v92
    v_fma_f32 v87, v86, v84, v87
    v_fma_f32 v94, v93, v84, v94
    v_fma_f32 v88, v85, v84, v88
    v_fma_f32 v95, v92, v84, v95
    v_cvt_pk_bf16_f32 v90, v87, v88
    v_cvt_pk_bf16_f32 v91, v94, v95
    ds_write_b64 v14, v[90:91] offset:368
    s_waitcnt lgkmcnt(0)
    ds_read_b128 v[96:99], v15 offset:256
    ds_read_b128 v[100:103], v15 offset:3456
    ds_read_b128 v[104:107], v15 offset:6656
    ds_read_b128 v[108:111], v15 offset:9856
    s_waitcnt lgkmcnt(3)
    buffer_store_dwordx4 v[96:99], v16, s[36:39], s60 offen offset:256
    s_waitcnt lgkmcnt(2)
    buffer_store_dwordx4 v[100:103], v16, s[36:39], s64 offen offset:256
    s_waitcnt lgkmcnt(1)
    buffer_store_dwordx4 v[104:107], v16, s[36:39], s65 offen offset:256
    s_waitcnt lgkmcnt(0)
    buffer_store_dwordx4 v[108:111], v16, s[36:39], s66 offen offset:256
    s_endpgm
L_exit:
    s_endpgm
.section .rodata,"a"
.p2align 6
.amdhsa_kernel rfa_partial_kernel
  .amdhsa_next_free_vgpr 256
  .amdhsa_next_free_sgpr 90
  .amdhsa_accum_offset 256
  .amdhsa_group_segment_fixed_size 0
  .amdhsa_kernarg_size 56
  .amdhsa_user_sgpr_count 2
  .amdhsa_user_sgpr_kernarg_segment_ptr 1
  .amdhsa_system_sgpr_workgroup_id_x 1
  .amdhsa_float_denorm_mode_32 3
  .amdhsa_float_denorm_mode_16_64 3
.end_amdhsa_kernel
.p2align 6
.amdhsa_kernel rfa_output_kernel
  .amdhsa_next_free_vgpr 256
  .amdhsa_next_free_sgpr 90
  .amdhsa_accum_offset 256
  .amdhsa_group_segment_fixed_size 0
  .amdhsa_kernarg_size 56
  .amdhsa_user_sgpr_count 2
  .amdhsa_user_sgpr_kernarg_segment_ptr 1
  .amdhsa_system_sgpr_workgroup_id_x 1
  .amdhsa_float_denorm_mode_32 3
  .amdhsa_float_denorm_mode_16_64 3
.end_amdhsa_kernel
```
